```python
import torch

def _softmax(x, axis=-1):
    return torch.softmax(x, dim=axis)
def _gelu(x):
    return torch.nn.functional.gelu(x, approximate="tanh")
def _silu(x):
    return torch.nn.functional.silu(x)
def _sigmoid(x):
    return torch.sigmoid(x)
def _layernorm(x, axis=-1, eps=1e-5):
    m = x.mean(dim=axis, keepdim=True)
    v = x.var(dim=axis, keepdim=True, unbiased=False)
    return (x - m) / torch.sqrt(v + eps)
def _scatter_add(tgt, idx, src, axis=0):
    return tgt.clone().index_add_(axis, idx, src)
def _segment_sum(src, seg, n):
    out = torch.zeros((n,) + src.shape[1:], dtype=src.dtype)
    return out.index_add_(0, seg, src)
def _pad(x, pw):
    flat = tuple(v for pair in reversed(pw) for v in pair)
    return torch.nn.functional.pad(x, flat)

kernel_name = 'concat_heads__mha_block_cached__gqa_block_cached__near_ridge'

def setup_inputs():

    _w = (lambda a: (lambda t: t.to(torch.bfloat16) if t.is_floating_point() else t)(torch.as_tensor(a)))
    def _A_setup():
        B, Sq, D = 16, 128, 512
        H, Sk, Dh = 32, 512, 128
        return {
            "x": _w((lambda *s: torch.randn(*s, dtype=torch.bfloat16) * 0.8)(B, Sq, D)),
            "k_cache": _w((lambda *s: torch.randn(*s, dtype=torch.bfloat16) * 0.8)(B, H, Sk, Dh)),
            "v_cache": _w((lambda *s: torch.randn(*s, dtype=torch.bfloat16) * 0.05)(B, H, Sk, Dh)),
            "wq": _w((lambda *s: torch.randn(*s, dtype=torch.bfloat16) * 0.8)(D, H * Dh) * (D ** -0.5)),
            "wo": _w((lambda *s: torch.randn(*s, dtype=torch.bfloat16) * 0.05)(H * Dh, D) * ((H * Dh) ** -0.5)),
        }
    _A_in = _A_setup()

    def _B_setup():
        B, Sq, D = 16, 128, 512
        Hq, Hkv, Sk, Dh = 32, 32, 512, 128
        assert Hq % Hkv == 0, (Hq, Hkv)
        return {
            "x": _w((lambda *s: torch.randn(*s, dtype=torch.bfloat16) * 0.8)(B, Sq, D)),
            "k_cache": _w((lambda *s: torch.randn(*s, dtype=torch.bfloat16) * 0.8)(B, Hkv, Sk, Dh)),
            "v_cache": _w((lambda *s: torch.randn(*s, dtype=torch.bfloat16) * 0.05)(B, Hkv, Sk, Dh)),
            "wq": _w((lambda *s: torch.randn(*s, dtype=torch.bfloat16) * 0.8)(D, Hq * Dh) * (D ** -0.5)),
            "wo": _w((lambda *s: torch.randn(*s, dtype=torch.bfloat16) * 0.05)(Hq * Dh, D) * ((Hq * Dh) ** -0.5)),
        }
    _B_in = _B_setup()

    return {
        "A_x": _A_in["x"],
        "A_k_cache": _A_in["k_cache"],
        "A_v_cache": _A_in["v_cache"],
        "A_wq": _A_in["wq"],
        "A_wo": _A_in["wo"],
        "B_x": _B_in["x"],
        "B_k_cache": _B_in["k_cache"],
        "B_v_cache": _B_in["v_cache"],
        "B_wq": _B_in["wq"],
        "B_wo": _B_in["wo"],
    }

def reference(A_x, A_k_cache, A_v_cache, A_wq, A_wo, B_x, B_k_cache, B_v_cache, B_wq, B_wo):
    def _A_ref(x, k_cache, v_cache, wq, wo):
        B, Sq, D = x.shape
        H, Dh = 32, 128
        q = (lambda x, *d: x.permute(*d))((x @ wq).reshape(B, Sq, H, Dh), 0, 2, 1, 3)
        scores = torch.einsum("bhqd,bhkd->bhqk", q, k_cache) * (Dh ** -0.5)
        p = _softmax(scores, axis=-1)
        o = torch.einsum("bhqk,bhkd->bhqd", p, v_cache)
        return (lambda x, *d: x.permute(*d))(o, 0, 2, 1, 3).reshape(B, Sq, H * Dh) @ wo

    def _B_ref(x, k_cache, v_cache, wq, wo):
        B, Sq, D = x.shape
        Hq, Dh = 32, 128
        Hkv = k_cache.shape[1]
        rep = Hq // Hkv
        q = (lambda x, *d: x.permute(*d))((x @ wq).reshape(B, Sq, Hq, Dh), 0, 2, 1, 3)
        k = (lambda x, n, axis: torch.repeat_interleave(x, n, dim=axis))(k_cache, rep, axis=1)
        v = (lambda x, n, axis: torch.repeat_interleave(x, n, dim=axis))(v_cache, rep, axis=1)
        scores = torch.einsum("bhqd,bhkd->bhqk", q, k) * (Dh ** -0.5)
        p = _softmax(scores, axis=-1)
        o = torch.einsum("bhqk,bhkd->bhqd", p, v)
        return (lambda x, *d: x.permute(*d))(o, 0, 2, 1, 3).reshape(B, Sq, Hq * Dh) @ wo

    a = _A_ref(A_x, A_k_cache, A_v_cache, A_wq, A_wo)
    b = _B_ref(B_x, B_k_cache, B_v_cache, B_wq, B_wo)
    return torch.concatenate([a, b], axis=-1)
```

```asm
; @launch kernel=prep_kernel grid=(1024,1,1) block=(256,1,1) lds=16384
; @launch kernel=attn_kernel grid=(1024,1,1) block=(256,1,1) lds=81920
; @launch kernel=oproj_kernel grid=(256,1,1) block=(256,1,1) lds=98304
.amdgcn_target "amdgcn-amd-amdhsa--gfx950"
.text
.globl prep_kernel
.type prep_kernel,@function
.globl attn_kernel
.type attn_kernel,@function
.globl oproj_kernel
.type oproj_kernel,@function
.p2align 8
prep_kernel:
    s_cmp_ge_u32 s2, 1024
    s_cbranch_scc1 L_prep_end
    s_load_dwordx16 s[16:31], s[0:1], 0
    s_load_dwordx4 s[32:35], s[0:1], 64
    s_load_dwordx2 s[36:37], s[0:1], 96
    v_lshrrev_b32 v1, 6, v0
    v_and_b32 v0, 63, v0
    v_readfirstlane_b32 s60, v1
    s_waitcnt lgkmcnt(0)
    s_mov_b32 s56, s36
    s_and_b32 s57, s37, 0xffff
    s_mov_b32 s58, 54525952
    s_mov_b32 s59, 0x00020000
    s_lshl_b32 s65, s60, 12
    v_lshlrev_b32 v2, 4, v0
    s_lshl_b32 s3, s2, 2
    s_add_u32 s3, s3, s60
    s_lshr_b32 s4, s3, 11
    s_cmp_eq_u32 s4, 0
    s_cselect_b64 s[10:11], s[16:17], s[26:27]
    s_mov_b32 s40, s10
    s_and_b32 s41, s11, 0xffff
    s_mov_b32 s42, 2097152
    s_mov_b32 s43, 0x00020000
    s_lshr_b32 s5, s3, 5
    s_and_b32 s5, s5, 63
    s_lshl_b32 s5, s5, 15
    s_and_b32 s6, s3, 31
    s_lshl_b32 s6, s6, 5
    s_add_u32 s5, s5, s6
    v_and_b32 v3, 31, v0
    v_lshlrev_b32 v3, 10, v3
    v_lshrrev_b32 v4, 5, v0
    v_lshlrev_b32 v4, 4, v4
    v_add_u32 v3, v3, v4
    buffer_load_dwordx4 v[60:63], v3, s[40:43], s5 offen offset:0 nt
    s_lshl_b32 s7, s3, 10
    s_add_u32 s7, s7, 50331648
    v_lshrrev_b32 v16, 2, v0
    v_and_b32 v16, 3, v16
    v_lshrrev_b32 v17, 4, v0
    v_and_b32 v17, 1, v17
    v_lshlrev_b32 v17, 5, v17
    v_and_b32 v18, 3, v0
    v_lshlrev_b32 v18, 3, v18
    v_add_u32 v17, v17, v18
    v_lshrrev_b32 v19, 5, v0
    s_mov_b32 m0, s65
    s_cmp_ge_u32 s2, 512
    s_cbranch_scc1 L_prep_wo
    s_lshr_b32 s4, s2, 8
    s_cmp_eq_u32 s4, 0
    s_cselect_b64 s[10:11], s[22:23], s[32:33]
    s_mov_b32 s44, s10
    s_and_b32 s45, s11, 0xffff
    s_mov_b32 s46, 4194304
    s_mov_b32 s47, 0x00020000
    s_lshr_b32 s8, s2, 3
    s_and_b32 s8, s8, 31
    s_and_b32 s9, s2, 7
    v_lshrrev_b32 v8, 4, v0
    v_and_b32 v9, 15, v0
    v_lshlrev_b32 v10, 2, v8
    v_xor_b32 v10, v10, v9
    v_lshlrev_b32 v10, 4, v10
    v_lshlrev_b32 v6, 13, v8
    v_add_u32 v6, v6, v10
    s_lshl_b32 s67, s60, 17
    v_add_u32 v6, s67, v6
    s_lshl_b32 s64, s9, 19
    s_lshl_b32 s61, s8, 8
    s_add_u32 s64, s64, s61
    s_add_u32 s62, s64, 0
    buffer_load_dwordx4 v6, s[44:47], s62 offen offset:0 nt lds
    s_add_u32 s62, s64, 31744
    buffer_load_dwordx4 v6, s[44:47], s62 offen offset:1024 nt lds
    s_add_u32 s62, s64, 63488
    buffer_load_dwordx4 v6, s[44:47], s62 offen offset:2048 nt lds
    s_add_u32 s62, s64, 95232
    buffer_load_dwordx4 v6, s[44:47], s62 offen offset:3072 nt lds
    v_lshlrev_b32 v20, 11, v19
    v_mul_u32_u24 v21, 0x140, v16
    v_add_u32 v20, v20, v21
    v_add_u32 v20, v20, v17
    v_add_u32 v24, s65, v20
    v_xor_b32 v25, 64, v24
    v_xor_b32 v26, 128, v24
    v_xor_b32 v27, 192, v24
    s_lshl_b32 s66, s4, 5
    s_add_u32 s66, s66, s8
    s_lshl_b32 s66, s66, 5
    s_lshl_b32 s61, s9, 2
    s_add_u32 s66, s66, s61
    s_add_u32 s66, s66, s60
    s_lshl_b32 s66, s66, 12
    s_add_u32 s66, s66, 41943040
    s_waitcnt vmcnt(0)
    s_barrier
    ds_read_b64_tr_b16 v[32:33], v24 offset:0
    ds_read_b64_tr_b16 v[34:35], v24 offset:1024
    ds_read_b64_tr_b16 v[36:37], v25 offset:0
    ds_read_b64_tr_b16 v[38:39], v25 offset:1024
    ds_read_b64_tr_b16 v[40:41], v26 offset:0
    ds_read_b64_tr_b16 v[42:43], v26 offset:1024
    ds_read_b64_tr_b16 v[44:45], v27 offset:0
    ds_read_b64_tr_b16 v[46:47], v27 offset:1024
    s_waitcnt lgkmcnt(6)
    buffer_store_dwordx4 v[32:35], v2, s[56:59], s66 offen offset:0
    s_waitcnt lgkmcnt(4)
    buffer_store_dwordx4 v[36:39], v2, s[56:59], s66 offen offset:1024
    s_waitcnt lgkmcnt(2)
    buffer_store_dwordx4 v[40:43], v2, s[56:59], s66 offen offset:2048
    s_waitcnt lgkmcnt(0)
    buffer_store_dwordx4 v[44:47], v2, s[56:59], s66 offen offset:3072
    buffer_store_dwordx4 v[60:63], v2, s[56:59], s7 offen offset:0
    s_endpgm
L_prep_wo:
    s_waitcnt vmcnt(0)
    buffer_store_dwordx4 v[60:63], v2, s[56:59], s7 offen offset:0
L_prep_end:
    s_endpgm
.p2align 8
attn_kernel:
    s_cmp_ge_u32 s2, 1024
    s_cbranch_scc1 L_attn_end
    s_load_dwordx16 s[16:31], s[0:1], 0
    s_load_dwordx4 s[32:35], s[0:1], 64
    s_load_dwordx2 s[36:37], s[0:1], 96
    s_and_b32 s3, s2, 7
    s_lshr_b32 s4, s2, 3
    s_lshr_b32 s5, s3, 2
    s_and_b32 s6, s3, 3
    s_lshr_b32 s7, s4, 3
    s_and_b32 s8, s4, 7
    s_lshl_b32 s6, s6, 3
    s_add_u32 s8, s8, s6
    v_lshrrev_b32 v1, 6, v0
    v_and_b32 v0, 63, v0
    v_readfirstlane_b32 s60, v1
    s_waitcnt lgkmcnt(0)
    s_cmp_eq_u32 s5, 0
    s_cselect_b64 s[10:11], s[16:17], s[26:27]
    s_cselect_b64 s[12:13], s[18:19], s[28:29]
    s_cselect_b64 s[14:15], s[20:21], s[30:31]
    s_cselect_b64 s[38:39], s[22:23], s[32:33]
    s_mov_b32 s40, s10
    s_and_b32 s41, s11, 0xffff
    s_mov_b32 s42, 2097152
    s_mov_b32 s43, 0x00020000
    s_mov_b32 s44, s12
    s_and_b32 s45, s13, 0xffff
    s_mov_b32 s46, 67108864
    s_mov_b32 s47, 0x00020000
    s_mov_b32 s48, s14
    s_and_b32 s49, s15, 0xffff
    s_mov_b32 s50, 67108864
    s_mov_b32 s51, 0x00020000
    s_mov_b32 s52, s38
    s_and_b32 s53, s39, 0xffff
    s_mov_b32 s54, 4194304
    s_mov_b32 s55, 0x00020000
    s_mov_b32 s56, s36
    s_and_b32 s57, s37, 0xffff
    s_mov_b32 s58, 54525952
    s_mov_b32 s59, 0x00020000
    s_lshr_b32 s72, s2, 9
    s_cmp_eq_u32 s72, 0
    s_cselect_b64 s[74:75], s[24:25], s[34:35]
    s_mov_b32 s76, s74
    s_and_b32 s77, s75, 0xffff
    s_mov_b32 s78, 4194304
    s_mov_b32 s79, 0x00020000
    s_lshl_b32 s61, s7, 5
    s_add_u32 s61, s61, s8
    s_lshl_b32 s61, s61, 17
    s_lshl_b32 s64, s8, 8
    s_lshl_b32 s65, s60, 12
    s_mov_b32 s63, 0x3e0293ee
    s_mov_b32 s66, 0xbe0293ee
    v_lshrrev_b32 v8, 4, v0
    v_and_b32 v9, 15, v0
    v_lshlrev_b32 v10, 2, v8
    v_xor_b32 v10, v10, v9
    v_lshlrev_b32 v10, 4, v10
    v_lshlrev_b32 v11, 8, v8
    v_add_u32 v1, v10, v11
    v_add_u32 v1, s65, v1
    v_lshlrev_b32 v6, 4, v0
    v_add_u32 v6, s65, v6
    s_lshl_b32 s64, s5, 5
    s_add_u32 s64, s64, s8
    s_lshl_b32 s64, s64, 17
    s_add_u32 s64, s64, 41943040
    v_xor_b32 v12, v9, v8
    v_lshlrev_b32 v12, 4, v12
    v_add_u32 v12, v12, v11
    v_add_u32 v2, s65, v12
    s_lshl_b32 s73, s5, 4
    s_add_u32 s73, s73, s7
    s_lshl_b32 s73, s73, 2
    s_add_u32 s73, s73, s60
    s_lshl_b32 s73, s73, 15
    s_add_u32 s73, s73, 50331648
    v_lshlrev_b32 v7, 4, v0
    s_add_u32 m0, s65, 0
    s_add_u32 s62, s64, 0
    buffer_load_dwordx4 v6, s[56:59], s62 offen offset:0 lds
    buffer_load_dwordx4 v6, s[56:59], s62 offen offset:1024 lds
    buffer_load_dwordx4 v6, s[56:59], s62 offen offset:2048 lds
    buffer_load_dwordx4 v6, s[56:59], s62 offen offset:3072 lds
    s_add_u32 s71, s73, 0
    buffer_load_dwordx4 v[128:131], v7, s[56:59], s71 offen offset:0
    buffer_load_dwordx4 v[132:135], v7, s[56:59], s71 offen offset:1024
    buffer_load_dwordx4 v[136:139], v7, s[56:59], s71 offen offset:2048
    buffer_load_dwordx4 v[140:143], v7, s[56:59], s71 offen offset:3072
    s_add_u32 s71, s73, 4096
    buffer_load_dwordx4 v[144:147], v7, s[56:59], s71 offen offset:0
    buffer_load_dwordx4 v[148:151], v7, s[56:59], s71 offen offset:1024
    buffer_load_dwordx4 v[152:155], v7, s[56:59], s71 offen offset:2048
    buffer_load_dwordx4 v[156:159], v7, s[56:59], s71 offen offset:3072
    s_add_u32 s71, s73, 8192
    buffer_load_dwordx4 v[160:163], v7, s[56:59], s71 offen offset:0
    buffer_load_dwordx4 v[164:167], v7, s[56:59], s71 offen offset:1024
    buffer_load_dwordx4 v[168:171], v7, s[56:59], s71 offen offset:2048
    buffer_load_dwordx4 v[172:175], v7, s[56:59], s71 offen offset:3072
    s_add_u32 s71, s73, 12288
    buffer_load_dwordx4 v[176:179], v7, s[56:59], s71 offen offset:0
    buffer_load_dwordx4 v[180:183], v7, s[56:59], s71 offen offset:1024
    buffer_load_dwordx4 v[184:187], v7, s[56:59], s71 offen offset:2048
    buffer_load_dwordx4 v[188:191], v7, s[56:59], s71 offen offset:3072
    s_add_u32 s71, s73, 16384
    buffer_load_dwordx4 v[192:195], v7, s[56:59], s71 offen offset:0
    buffer_load_dwordx4 v[196:199], v7, s[56:59], s71 offen offset:1024
    buffer_load_dwordx4 v[200:203], v7, s[56:59], s71 offen offset:2048
    buffer_load_dwordx4 v[204:207], v7, s[56:59], s71 offen offset:3072
    s_add_u32 s71, s73, 20480
    buffer_load_dwordx4 v[208:211], v7, s[56:59], s71 offen offset:0
    buffer_load_dwordx4 v[212:215], v7, s[56:59], s71 offen offset:1024
    buffer_load_dwordx4 v[216:219], v7, s[56:59], s71 offen offset:2048
    buffer_load_dwordx4 v[220:223], v7, s[56:59], s71 offen offset:3072
    s_add_u32 s71, s73, 24576
    buffer_load_dwordx4 v[224:227], v7, s[56:59], s71 offen offset:0
    buffer_load_dwordx4 v[228:231], v7, s[56:59], s71 offen offset:1024
    buffer_load_dwordx4 v[232:235], v7, s[56:59], s71 offen offset:2048
    buffer_load_dwordx4 v[236:239], v7, s[56:59], s71 offen offset:3072
    s_add_u32 s71, s73, 28672
    buffer_load_dwordx4 v[240:243], v7, s[56:59], s71 offen offset:0
    buffer_load_dwordx4 v[244:247], v7, s[56:59], s71 offen offset:1024
    buffer_load_dwordx4 v[248:251], v7, s[56:59], s71 offen offset:2048
    buffer_load_dwordx4 v[252:255], v7, s[56:59], s71 offen offset:3072
    s_add_u32 m0, s65, 16384
    s_add_u32 s62, s64, 16384
    buffer_load_dwordx4 v6, s[56:59], s62 offen offset:0 lds
    buffer_load_dwordx4 v6, s[56:59], s62 offen offset:1024 lds
    buffer_load_dwordx4 v6, s[56:59], s62 offen offset:2048 lds
    buffer_load_dwordx4 v6, s[56:59], s62 offen offset:3072 lds
    s_add_u32 m0, s65, 32768
    s_add_u32 s62, s64, 32768
    buffer_load_dwordx4 v6, s[56:59], s62 offen offset:0 lds
    buffer_load_dwordx4 v6, s[56:59], s62 offen offset:1024 lds
    buffer_load_dwordx4 v6, s[56:59], s62 offen offset:2048 lds
    buffer_load_dwordx4 v6, s[56:59], s62 offen offset:3072 lds
    s_add_u32 m0, s65, 49152
    s_add_u32 s62, s61, 0
    buffer_load_dwordx4 v2, s[44:47], s62 offen offset:0 nt lds
    v_xor_b32 v3, 64, v2
    buffer_load_dwordx4 v3, s[44:47], s62 offen offset:1024 nt lds
    v_xor_b32 v3, 128, v2
    buffer_load_dwordx4 v3, s[44:47], s62 offen offset:2048 nt lds
    v_xor_b32 v3, 192, v2
    buffer_load_dwordx4 v3, s[44:47], s62 offen offset:3072 nt lds
    s_add_u32 m0, s65, 65536
    s_add_u32 s62, s61, 16384
    buffer_load_dwordx4 v2, s[44:47], s62 offen offset:0 nt lds
    v_xor_b32 v3, 64, v2
    buffer_load_dwordx4 v3, s[44:47], s62 offen offset:1024 nt lds
    v_xor_b32 v3, 128, v2
    buffer_load_dwordx4 v3, s[44:47], s62 offen offset:2048 nt lds
    v_xor_b32 v3, 192, v2
    buffer_load_dwordx4 v3, s[44:47], s62 offen offset:3072 nt lds
    v_lshlrev_b32 v24, 4, v0
    v_add_u32 v28, 0x8000, v24
    s_waitcnt vmcnt(48)
    s_barrier
    ds_read_b128 v[32:35], v24 offset:0
    ds_read_b128 v[36:39], v24 offset:1024
    ds_read_b128 v[40:43], v24 offset:2048
    ds_read_b128 v[44:47], v24 offset:3072
    ds_read_b128 v[48:51], v24 offset:4096
    ds_read_b128 v[52:55], v24 offset:5120
    ds_read_b128 v[56:59], v24 offset:6144
    s_waitcnt vmcnt(47) lgkmcnt(6)
    v_mfma_f32_32x32x16_bf16 v[64:79], v[32:35], v[128:131], 0
    ds_read_b128 v[60:63], v24 offset:7168
    s_waitcnt lgkmcnt(6)
    v_mfma_f32_32x32x16_bf16 v[80:95], v[36:39], v[128:131], 0
    ds_read_b128 v[32:35], v24 offset:8192
    s_waitcnt lgkmcnt(6)
    v_mfma_f32_32x32x16_bf16 v[96:111], v[40:43], v[128:131], 0
    ds_read_b128 v[36:39], v24 offset:9216
    s_waitcnt lgkmcnt(6)
    v_mfma_f32_32x32x16_bf16 v[112:127], v[44:47], v[128:131], 0
    ds_read_b128 v[40:43], v24 offset:10240
    s_waitcnt vmcnt(46) lgkmcnt(6)
    v_mfma_f32_32x32x16_bf16 v[64:79], v[48:51], v[132:135], v[64:79]
    ds_read_b128 v[44:47], v24 offset:11264
    s_waitcnt lgkmcnt(6)
    v_mfma_f32_32x32x16_bf16 v[80:95], v[52:55], v[132:135], v[80:95]
    ds_read_b128 v[48:51], v24 offset:12288
    s_waitcnt lgkmcnt(6)
    v_mfma_f32_32x32x16_bf16 v[96:111], v[56:59], v[132:135], v[96:111]
    ds_read_b128 v[52:55], v24 offset:13312
    s_waitcnt lgkmcnt(6)
    v_mfma_f32_32x32x16_bf16 v[112:127], v[60:63], v[132:135], v[112:127]
    ds_read_b128 v[56:59], v24 offset:14336
    s_waitcnt vmcnt(45) lgkmcnt(6)
    v_mfma_f32_32x32x16_bf16 v[64:79], v[32:35], v[136:139], v[64:79]
    ds_read_b128 v[60:63], v24 offset:15360
    s_waitcnt lgkmcnt(6)
    v_mfma_f32_32x32x16_bf16 v[80:95], v[36:39], v[136:139], v[80:95]
    s_waitcnt lgkmcnt(5)
    v_mfma_f32_32x32x16_bf16 v[96:111], v[40:43], v[136:139], v[96:111]
    s_waitcnt lgkmcnt(4)
    v_mfma_f32_32x32x16_bf16 v[112:127], v[44:47], v[136:139], v[112:127]
    s_waitcnt vmcnt(44) lgkmcnt(3)
    v_mfma_f32_32x32x16_bf16 v[64:79], v[48:51], v[140:143], v[64:79]
    s_waitcnt lgkmcnt(2)
    v_mfma_f32_32x32x16_bf16 v[80:95], v[52:55], v[140:143], v[80:95]
    s_waitcnt lgkmcnt(1)
    v_mfma_f32_32x32x16_bf16 v[96:111], v[56:59], v[140:143], v[96:111]
    s_waitcnt lgkmcnt(0)
    v_mfma_f32_32x32x16_bf16 v[112:127], v[60:63], v[140:143], v[112:127]
    s_waitcnt vmcnt(12)
    s_barrier
    s_add_u32 m0, s65, 0
    s_add_u32 s62, s64, 49152
    buffer_load_dwordx4 v6, s[56:59], s62 offen offset:0 lds
    buffer_load_dwordx4 v6, s[56:59], s62 offen offset:1024 lds
    buffer_load_dwordx4 v6, s[56:59], s62 offen offset:2048 lds
    buffer_load_dwordx4 v6, s[56:59], s62 offen offset:3072 lds
    ds_read_b128 v[32:35], v24 offset:16384
    ds_read_b128 v[36:39], v24 offset:17408
    ds_read_b128 v[40:43], v24 offset:18432
    ds_read_b128 v[44:47], v24 offset:19456
    ds_read_b128 v[48:51], v24 offset:20480
    ds_read_b128 v[52:55], v24 offset:21504
    ds_read_b128 v[56:59], v24 offset:22528
    s_waitcnt lgkmcnt(6)
    v_mfma_f32_32x32x16_bf16 v[64:79], v[32:35], v[144:147], v[64:79]
    ds_read_b128 v[60:63], v24 offset:23552
    s_waitcnt lgkmcnt(6)
    v_mfma_f32_32x32x16_bf16 v[80:95], v[36:39], v[144:147], v[80:95]
    ds_read_b128 v[32:35], v24 offset:24576
    s_waitcnt lgkmcnt(6)
    v_mfma_f32_32x32x16_bf16 v[96:111], v[40:43], v[144:147], v[96:111]
    ds_read_b128 v[36:39], v24 offset:25600
    s_waitcnt lgkmcnt(6)
    v_mfma_f32_32x32x16_bf16 v[112:127], v[44:47], v[144:147], v[112:127]
    ds_read_b128 v[40:43], v24 offset:26624
    s_waitcnt lgkmcnt(6)
    v_mfma_f32_32x32x16_bf16 v[64:79], v[48:51], v[148:151], v[64:79]
    ds_read_b128 v[44:47], v24 offset:27648
    s_waitcnt lgkmcnt(6)
    v_mfma_f32_32x32x16_bf16 v[80:95], v[52:55], v[148:151], v[80:95]
    ds_read_b128 v[48:51], v24 offset:28672
    s_waitcnt lgkmcnt(6)
    v_mfma_f32_32x32x16_bf16 v[96:111], v[56:59], v[148:151], v[96:111]
    ds_read_b128 v[52:55], v24 offset:29696
    s_waitcnt lgkmcnt(6)
    v_mfma_f32_32x32x16_bf16 v[112:127], v[60:63], v[148:151], v[112:127]
    ds_read_b128 v[56:59], v24 offset:30720
    s_waitcnt lgkmcnt(6)
    v_mfma_f32_32x32x16_bf16 v[64:79], v[32:35], v[152:155], v[64:79]
    ds_read_b128 v[60:63], v24 offset:31744
    s_waitcnt lgkmcnt(6)
    v_mfma_f32_32x32x16_bf16 v[80:95], v[36:39], v[152:155], v[80:95]
    s_waitcnt lgkmcnt(5)
    v_mfma_f32_32x32x16_bf16 v[96:111], v[40:43], v[152:155], v[96:111]
    s_waitcnt lgkmcnt(4)
    v_mfma_f32_32x32x16_bf16 v[112:127], v[44:47], v[152:155], v[112:127]
    s_waitcnt lgkmcnt(3)
    v_mfma_f32_32x32x16_bf16 v[64:79], v[48:51], v[156:159], v[64:79]
    s_waitcnt lgkmcnt(2)
    v_mfma_f32_32x32x16_bf16 v[80:95], v[52:55], v[156:159], v[80:95]
    s_waitcnt lgkmcnt(1)
    v_mfma_f32_32x32x16_bf16 v[96:111], v[56:59], v[156:159], v[96:111]
    s_waitcnt lgkmcnt(0)
    v_mfma_f32_32x32x16_bf16 v[112:127], v[60:63], v[156:159], v[112:127]
    s_waitcnt vmcnt(12)
    s_barrier
    s_add_u32 m0, s65, 16384
    s_add_u32 s62, s64, 65536
    buffer_load_dwordx4 v6, s[56:59], s62 offen offset:0 lds
    buffer_load_dwordx4 v6, s[56:59], s62 offen offset:1024 lds
    buffer_load_dwordx4 v6, s[56:59], s62 offen offset:2048 lds
    buffer_load_dwordx4 v6, s[56:59], s62 offen offset:3072 lds
    ds_read_b128 v[32:35], v28 offset:0
    ds_read_b128 v[36:39], v28 offset:1024
    ds_read_b128 v[40:43], v28 offset:2048
    ds_read_b128 v[44:47], v28 offset:3072
    ds_read_b128 v[48:51], v28 offset:4096
    ds_read_b128 v[52:55], v28 offset:5120
    ds_read_b128 v[56:59], v28 offset:6144
    s_waitcnt lgkmcnt(6)
    v_mfma_f32_32x32x16_bf16 v[64:79], v[32:35], v[160:163], v[64:79]
    ds_read_b128 v[60:63], v28 offset:7168
    s_waitcnt lgkmcnt(6)
    v_mfma_f32_32x32x16_bf16 v[80:95], v[36:39], v[160:163], v[80:95]
    ds_read_b128 v[32:35], v28 offset:8192
    s_waitcnt lgkmcnt(6)
    v_mfma_f32_32x32x16_bf16 v[96:111], v[40:43], v[160:163], v[96:111]
    ds_read_b128 v[36:39], v28 offset:9216
    s_waitcnt lgkmcnt(6)
    v_mfma_f32_32x32x16_bf16 v[112:127], v[44:47], v[160:163], v[112:127]
    ds_read_b128 v[40:43], v28 offset:10240
    s_waitcnt lgkmcnt(6)
    v_mfma_f32_32x32x16_bf16 v[64:79], v[48:51], v[164:167], v[64:79]
    ds_read_b128 v[44:47], v28 offset:11264
    s_waitcnt lgkmcnt(6)
    v_mfma_f32_32x32x16_bf16 v[80:95], v[52:55], v[164:167], v[80:95]
    ds_read_b128 v[48:51], v28 offset:12288
    s_waitcnt lgkmcnt(6)
    v_mfma_f32_32x32x16_bf16 v[96:111], v[56:59], v[164:167], v[96:111]
    ds_read_b128 v[52:55], v28 offset:13312
    s_waitcnt lgkmcnt(6)
    v_mfma_f32_32x32x16_bf16 v[112:127], v[60:63], v[164:167], v[112:127]
    ds_read_b128 v[56:59], v28 offset:14336
    s_waitcnt lgkmcnt(6)
    v_mfma_f32_32x32x16_bf16 v[64:79], v[32:35], v[168:171], v[64:79]
    ds_read_b128 v[60:63], v28 offset:15360
    s_waitcnt lgkmcnt(6)
    v_mfma_f32_32x32x16_bf16 v[80:95], v[36:39], v[168:171], v[80:95]
    s_waitcnt lgkmcnt(5)
    v_mfma_f32_32x32x16_bf16 v[96:111], v[40:43], v[168:171], v[96:111]
    s_waitcnt lgkmcnt(4)
    v_mfma_f32_32x32x16_bf16 v[112:127], v[44:47], v[168:171], v[112:127]
    s_waitcnt lgkmcnt(3)
    v_mfma_f32_32x32x16_bf16 v[64:79], v[48:51], v[172:175], v[64:79]
    s_waitcnt lgkmcnt(2)
    v_mfma_f32_32x32x16_bf16 v[80:95], v[52:55], v[172:175], v[80:95]
    s_waitcnt lgkmcnt(1)
    v_mfma_f32_32x32x16_bf16 v[96:111], v[56:59], v[172:175], v[96:111]
    s_waitcnt lgkmcnt(0)
    v_mfma_f32_32x32x16_bf16 v[112:127], v[60:63], v[172:175], v[112:127]
    s_waitcnt vmcnt(4)
    s_barrier
    s_add_u32 m0, s65, 32768
    s_add_u32 s62, s64, 81920
    buffer_load_dwordx4 v6, s[56:59], s62 offen offset:0 lds
    buffer_load_dwordx4 v6, s[56:59], s62 offen offset:1024 lds
    buffer_load_dwordx4 v6, s[56:59], s62 offen offset:2048 lds
    buffer_load_dwordx4 v6, s[56:59], s62 offen offset:3072 lds
    ds_read_b128 v[32:35], v24 offset:0
    ds_read_b128 v[36:39], v24 offset:1024
    ds_read_b128 v[40:43], v24 offset:2048
    ds_read_b128 v[44:47], v24 offset:3072
    ds_read_b128 v[48:51], v24 offset:4096
    ds_read_b128 v[52:55], v24 offset:5120
    ds_read_b128 v[56:59], v24 offset:6144
    s_waitcnt lgkmcnt(6)
    v_mfma_f32_32x32x16_bf16 v[64:79], v[32:35], v[176:179], v[64:79]
    ds_read_b128 v[60:63], v24 offset:7168
    s_waitcnt lgkmcnt(6)
    v_mfma_f32_32x32x16_bf16 v[80:95], v[36:39], v[176:179], v[80:95]
    ds_read_b128 v[32:35], v24 offset:8192
    s_waitcnt lgkmcnt(6)
    v_mfma_f32_32x32x16_bf16 v[96:111], v[40:43], v[176:179], v[96:111]
    ds_read_b128 v[36:39], v24 offset:9216
    s_waitcnt lgkmcnt(6)
    v_mfma_f32_32x32x16_bf16 v[112:127], v[44:47], v[176:179], v[112:127]
    ds_read_b128 v[40:43], v24 offset:10240
    s_waitcnt lgkmcnt(6)
    v_mfma_f32_32x32x16_bf16 v[64:79], v[48:51], v[180:183], v[64:79]
    ds_read_b128 v[44:47], v24 offset:11264
    s_waitcnt lgkmcnt(6)
    v_mfma_f32_32x32x16_bf16 v[80:95], v[52:55], v[180:183], v[80:95]
    ds_read_b128 v[48:51], v24 offset:12288
    s_waitcnt lgkmcnt(6)
    v_mfma_f32_32x32x16_bf16 v[96:111], v[56:59], v[180:183], v[96:111]
    ds_read_b128 v[52:55], v24 offset:13312
    s_waitcnt lgkmcnt(6)
    v_mfma_f32_32x32x16_bf16 v[112:127], v[60:63], v[180:183], v[112:127]
    ds_read_b128 v[56:59], v24 offset:14336
    s_waitcnt lgkmcnt(6)
    v_mfma_f32_32x32x16_bf16 v[64:79], v[32:35], v[184:187], v[64:79]
    ds_read_b128 v[60:63], v24 offset:15360
    s_waitcnt lgkmcnt(6)
    v_mfma_f32_32x32x16_bf16 v[80:95], v[36:39], v[184:187], v[80:95]
    s_waitcnt lgkmcnt(5)
    v_mfma_f32_32x32x16_bf16 v[96:111], v[40:43], v[184:187], v[96:111]
    s_waitcnt lgkmcnt(4)
    v_mfma_f32_32x32x16_bf16 v[112:127], v[44:47], v[184:187], v[112:127]
    s_waitcnt lgkmcnt(3)
    v_mfma_f32_32x32x16_bf16 v[64:79], v[48:51], v[188:191], v[64:79]
    s_waitcnt lgkmcnt(2)
    v_mfma_f32_32x32x16_bf16 v[80:95], v[52:55], v[188:191], v[80:95]
    s_waitcnt lgkmcnt(1)
    v_mfma_f32_32x32x16_bf16 v[96:111], v[56:59], v[188:191], v[96:111]
    s_waitcnt lgkmcnt(0)
    v_mfma_f32_32x32x16_bf16 v[112:127], v[60:63], v[188:191], v[112:127]
    s_waitcnt vmcnt(4)
    s_barrier
    s_add_u32 m0, s65, 0
    s_add_u32 s62, s64, 98304
    buffer_load_dwordx4 v6, s[56:59], s62 offen offset:0 lds
    buffer_load_dwordx4 v6, s[56:59], s62 offen offset:1024 lds
    buffer_load_dwordx4 v6, s[56:59], s62 offen offset:2048 lds
    buffer_load_dwordx4 v6, s[56:59], s62 offen offset:3072 lds
    ds_read_b128 v[32:35], v24 offset:16384
    ds_read_b128 v[36:39], v24 offset:17408
    ds_read_b128 v[40:43], v24 offset:18432
    ds_read_b128 v[44:47], v24 offset:19456
    ds_read_b128 v[48:51], v24 offset:20480
    ds_read_b128 v[52:55], v24 offset:21504
    ds_read_b128 v[56:59], v24 offset:22528
    s_waitcnt lgkmcnt(6)
    v_mfma_f32_32x32x16_bf16 v[64:79], v[32:35], v[192:195], v[64:79]
    ds_read_b128 v[60:63], v24 offset:23552
    s_waitcnt lgkmcnt(6)
    v_mfma_f32_32x32x16_bf16 v[80:95], v[36:39], v[192:195], v[80:95]
    ds_read_b128 v[32:35], v24 offset:24576
    s_waitcnt lgkmcnt(6)
    v_mfma_f32_32x32x16_bf16 v[96:111], v[40:43], v[192:195], v[96:111]
    ds_read_b128 v[36:39], v24 offset:25600
    s_waitcnt lgkmcnt(6)
    v_mfma_f32_32x32x16_bf16 v[112:127], v[44:47], v[192:195], v[112:127]
    ds_read_b128 v[40:43], v24 offset:26624
    s_waitcnt lgkmcnt(6)
    v_mfma_f32_32x32x16_bf16 v[64:79], v[48:51], v[196:199], v[64:79]
    ds_read_b128 v[44:47], v24 offset:27648
    s_waitcnt lgkmcnt(6)
    v_mfma_f32_32x32x16_bf16 v[80:95], v[52:55], v[196:199], v[80:95]
    ds_read_b128 v[48:51], v24 offset:28672
    s_waitcnt lgkmcnt(6)
    v_mfma_f32_32x32x16_bf16 v[96:111], v[56:59], v[196:199], v[96:111]
    ds_read_b128 v[52:55], v24 offset:29696
    s_waitcnt lgkmcnt(6)
    v_mfma_f32_32x32x16_bf16 v[112:127], v[60:63], v[196:199], v[112:127]
    ds_read_b128 v[56:59], v24 offset:30720
    s_waitcnt lgkmcnt(6)
    v_mfma_f32_32x32x16_bf16 v[64:79], v[32:35], v[200:203], v[64:79]
    ds_read_b128 v[60:63], v24 offset:31744
    s_waitcnt lgkmcnt(6)
    v_mfma_f32_32x32x16_bf16 v[80:95], v[36:39], v[200:203], v[80:95]
    s_waitcnt lgkmcnt(5)
    v_mfma_f32_32x32x16_bf16 v[96:111], v[40:43], v[200:203], v[96:111]
    s_waitcnt lgkmcnt(4)
    v_mfma_f32_32x32x16_bf16 v[112:127], v[44:47], v[200:203], v[112:127]
    s_waitcnt lgkmcnt(3)
    v_mfma_f32_32x32x16_bf16 v[64:79], v[48:51], v[204:207], v[64:79]
    s_waitcnt lgkmcnt(2)
    v_mfma_f32_32x32x16_bf16 v[80:95], v[52:55], v[204:207], v[80:95]
    s_waitcnt lgkmcnt(1)
    v_mfma_f32_32x32x16_bf16 v[96:111], v[56:59], v[204:207], v[96:111]
    s_waitcnt lgkmcnt(0)
    v_mfma_f32_32x32x16_bf16 v[112:127], v[60:63], v[204:207], v[112:127]
    s_waitcnt vmcnt(4)
    s_barrier
    s_add_u32 m0, s65, 16384
    s_add_u32 s62, s64, 114688
    buffer_load_dwordx4 v6, s[56:59], s62 offen offset:0 lds
    buffer_load_dwordx4 v6, s[56:59], s62 offen offset:1024 lds
    buffer_load_dwordx4 v6, s[56:59], s62 offen offset:2048 lds
    buffer_load_dwordx4 v6, s[56:59], s62 offen offset:3072 lds
    ds_read_b128 v[32:35], v28 offset:0
    ds_read_b128 v[36:39], v28 offset:1024
    ds_read_b128 v[40:43], v28 offset:2048
    ds_read_b128 v[44:47], v28 offset:3072
    ds_read_b128 v[48:51], v28 offset:4096
    ds_read_b128 v[52:55], v28 offset:5120
    ds_read_b128 v[56:59], v28 offset:6144
    s_waitcnt lgkmcnt(6)
    v_mfma_f32_32x32x16_bf16 v[64:79], v[32:35], v[208:211], v[64:79]
    ds_read_b128 v[60:63], v28 offset:7168
    s_waitcnt lgkmcnt(6)
    v_mfma_f32_32x32x16_bf16 v[80:95], v[36:39], v[208:211], v[80:95]
    ds_read_b128 v[32:35], v28 offset:8192
    s_waitcnt lgkmcnt(6)
    v_mfma_f32_32x32x16_bf16 v[96:111], v[40:43], v[208:211], v[96:111]
    ds_read_b128 v[36:39], v28 offset:9216
    s_waitcnt lgkmcnt(6)
    v_mfma_f32_32x32x16_bf16 v[112:127], v[44:47], v[208:211], v[112:127]
    ds_read_b128 v[40:43], v28 offset:10240
    s_waitcnt lgkmcnt(6)
    v_mfma_f32_32x32x16_bf16 v[64:79], v[48:51], v[212:215], v[64:79]
    ds_read_b128 v[44:47], v28 offset:11264
    s_waitcnt lgkmcnt(6)
    v_mfma_f32_32x32x16_bf16 v[80:95], v[52:55], v[212:215], v[80:95]
    ds_read_b128 v[48:51], v28 offset:12288
    s_waitcnt lgkmcnt(6)
    v_mfma_f32_32x32x16_bf16 v[96:111], v[56:59], v[212:215], v[96:111]
    ds_read_b128 v[52:55], v28 offset:13312
    s_waitcnt lgkmcnt(6)
    v_mfma_f32_32x32x16_bf16 v[112:127], v[60:63], v[212:215], v[112:127]
    ds_read_b128 v[56:59], v28 offset:14336
    s_waitcnt lgkmcnt(6)
    v_mfma_f32_32x32x16_bf16 v[64:79], v[32:35], v[216:219], v[64:79]
    ds_read_b128 v[60:63], v28 offset:15360
    s_waitcnt lgkmcnt(6)
    v_mfma_f32_32x32x16_bf16 v[80:95], v[36:39], v[216:219], v[80:95]
    s_waitcnt lgkmcnt(5)
    v_mfma_f32_32x32x16_bf16 v[96:111], v[40:43], v[216:219], v[96:111]
    s_waitcnt lgkmcnt(4)
    v_mfma_f32_32x32x16_bf16 v[112:127], v[44:47], v[216:219], v[112:127]
    s_waitcnt lgkmcnt(3)
    v_mfma_f32_32x32x16_bf16 v[64:79], v[48:51], v[220:223], v[64:79]
    s_waitcnt lgkmcnt(2)
    v_mfma_f32_32x32x16_bf16 v[80:95], v[52:55], v[220:223], v[80:95]
    s_waitcnt lgkmcnt(1)
    v_mfma_f32_32x32x16_bf16 v[96:111], v[56:59], v[220:223], v[96:111]
    s_waitcnt lgkmcnt(0)
    v_mfma_f32_32x32x16_bf16 v[112:127], v[60:63], v[220:223], v[112:127]
    s_waitcnt vmcnt(4)
    s_barrier
    s_add_u32 m0, s65, 32768
    s_add_u32 s62, s61, 32768
    buffer_load_dwordx4 v2, s[44:47], s62 offen offset:0 nt lds
    v_xor_b32 v3, 64, v2
    buffer_load_dwordx4 v3, s[44:47], s62 offen offset:1024 nt lds
    v_xor_b32 v3, 128, v2
    buffer_load_dwordx4 v3, s[44:47], s62 offen offset:2048 nt lds
    v_xor_b32 v3, 192, v2
    buffer_load_dwordx4 v3, s[44:47], s62 offen offset:3072 nt lds
    ds_read_b128 v[32:35], v24 offset:0
    ds_read_b128 v[36:39], v24 offset:1024
    ds_read_b128 v[40:43], v24 offset:2048
    ds_read_b128 v[44:47], v24 offset:3072
    ds_read_b128 v[48:51], v24 offset:4096
    ds_read_b128 v[52:55], v24 offset:5120
    ds_read_b128 v[56:59], v24 offset:6144
    s_waitcnt lgkmcnt(6)
    v_mfma_f32_32x32x16_bf16 v[64:79], v[32:35], v[224:227], v[64:79]
    ds_read_b128 v[60:63], v24 offset:7168
    s_waitcnt lgkmcnt(6)
    v_mfma_f32_32x32x16_bf16 v[80:95], v[36:39], v[224:227], v[80:95]
    ds_read_b128 v[32:35], v24 offset:8192
    s_waitcnt lgkmcnt(6)
    v_mfma_f32_32x32x16_bf16 v[96:111], v[40:43], v[224:227], v[96:111]
    ds_read_b128 v[36:39], v24 offset:9216
    s_waitcnt lgkmcnt(6)
    v_mfma_f32_32x32x16_bf16 v[112:127], v[44:47], v[224:227], v[112:127]
    ds_read_b128 v[40:43], v24 offset:10240
    s_waitcnt lgkmcnt(6)
    v_mfma_f32_32x32x16_bf16 v[64:79], v[48:51], v[228:231], v[64:79]
    ds_read_b128 v[44:47], v24 offset:11264
    s_waitcnt lgkmcnt(6)
    v_mfma_f32_32x32x16_bf16 v[80:95], v[52:55], v[228:231], v[80:95]
    ds_read_b128 v[48:51], v24 offset:12288
    s_waitcnt lgkmcnt(6)
    v_mfma_f32_32x32x16_bf16 v[96:111], v[56:59], v[228:231], v[96:111]
    ds_read_b128 v[52:55], v24 offset:13312
    s_waitcnt lgkmcnt(6)
    v_mfma_f32_32x32x16_bf16 v[112:127], v[60:63], v[228:231], v[112:127]
    ds_read_b128 v[56:59], v24 offset:14336
    s_waitcnt lgkmcnt(6)
    v_mfma_f32_32x32x16_bf16 v[64:79], v[32:35], v[232:235], v[64:79]
    ds_read_b128 v[60:63], v24 offset:15360
    s_waitcnt lgkmcnt(6)
    v_mfma_f32_32x32x16_bf16 v[80:95], v[36:39], v[232:235], v[80:95]
    s_waitcnt lgkmcnt(5)
    v_mfma_f32_32x32x16_bf16 v[96:111], v[40:43], v[232:235], v[96:111]
    s_waitcnt lgkmcnt(4)
    v_mfma_f32_32x32x16_bf16 v[112:127], v[44:47], v[232:235], v[112:127]
    s_waitcnt lgkmcnt(3)
    v_mfma_f32_32x32x16_bf16 v[64:79], v[48:51], v[236:239], v[64:79]
    s_waitcnt lgkmcnt(2)
    v_mfma_f32_32x32x16_bf16 v[80:95], v[52:55], v[236:239], v[80:95]
    s_waitcnt lgkmcnt(1)
    v_mfma_f32_32x32x16_bf16 v[96:111], v[56:59], v[236:239], v[96:111]
    s_waitcnt lgkmcnt(0)
    v_mfma_f32_32x32x16_bf16 v[112:127], v[60:63], v[236:239], v[112:127]
    s_waitcnt vmcnt(4)
    s_barrier
    s_add_u32 m0, s65, 0
    s_add_u32 s62, s61, 49152
    buffer_load_dwordx4 v2, s[44:47], s62 offen offset:0 nt lds
    v_xor_b32 v3, 64, v2
    buffer_load_dwordx4 v3, s[44:47], s62 offen offset:1024 nt lds
    v_xor_b32 v3, 128, v2
    buffer_load_dwordx4 v3, s[44:47], s62 offen offset:2048 nt lds
    v_xor_b32 v3, 192, v2
    buffer_load_dwordx4 v3, s[44:47], s62 offen offset:3072 nt lds
    ds_read_b128 v[32:35], v24 offset:16384
    ds_read_b128 v[36:39], v24 offset:17408
    ds_read_b128 v[40:43], v24 offset:18432
    ds_read_b128 v[44:47], v24 offset:19456
    ds_read_b128 v[48:51], v24 offset:20480
    ds_read_b128 v[52:55], v24 offset:21504
    ds_read_b128 v[56:59], v24 offset:22528
    s_waitcnt lgkmcnt(6)
    v_mfma_f32_32x32x16_bf16 v[64:79], v[32:35], v[240:243], v[64:79]
    ds_read_b128 v[60:63], v24 offset:23552
    s_waitcnt lgkmcnt(6)
    v_mfma_f32_32x32x16_bf16 v[80:95], v[36:39], v[240:243], v[80:95]
    ds_read_b128 v[32:35], v24 offset:24576
    s_waitcnt lgkmcnt(6)
    v_mfma_f32_32x32x16_bf16 v[96:111], v[40:43], v[240:243], v[96:111]
    ds_read_b128 v[36:39], v24 offset:25600
    s_waitcnt lgkmcnt(6)
    v_mfma_f32_32x32x16_bf16 v[112:127], v[44:47], v[240:243], v[112:127]
    ds_read_b128 v[40:43], v24 offset:26624
    s_waitcnt lgkmcnt(6)
    v_mfma_f32_32x32x16_bf16 v[64:79], v[48:51], v[244:247], v[64:79]
    ds_read_b128 v[44:47], v24 offset:27648
    s_waitcnt lgkmcnt(6)
    v_mfma_f32_32x32x16_bf16 v[80:95], v[52:55], v[244:247], v[80:95]
    ds_read_b128 v[48:51], v24 offset:28672
    s_waitcnt lgkmcnt(6)
    v_mfma_f32_32x32x16_bf16 v[96:111], v[56:59], v[244:247], v[96:111]
    ds_read_b128 v[52:55], v24 offset:29696
    s_waitcnt lgkmcnt(6)
    v_mfma_f32_32x32x16_bf16 v[112:127], v[60:63], v[244:247], v[112:127]
    ds_read_b128 v[56:59], v24 offset:30720
    s_waitcnt lgkmcnt(6)
    v_mfma_f32_32x32x16_bf16 v[64:79], v[32:35], v[248:251], v[64:79]
    ds_read_b128 v[60:63], v24 offset:31744
    s_waitcnt lgkmcnt(6)
    v_mfma_f32_32x32x16_bf16 v[80:95], v[36:39], v[248:251], v[80:95]
    s_waitcnt lgkmcnt(5)
    v_mfma_f32_32x32x16_bf16 v[96:111], v[40:43], v[248:251], v[96:111]
    s_waitcnt lgkmcnt(4)
    v_mfma_f32_32x32x16_bf16 v[112:127], v[44:47], v[248:251], v[112:127]
    s_waitcnt lgkmcnt(3)
    v_mfma_f32_32x32x16_bf16 v[64:79], v[48:51], v[252:255], v[64:79]
    s_waitcnt lgkmcnt(2)
    v_mfma_f32_32x32x16_bf16 v[80:95], v[52:55], v[252:255], v[80:95]
    s_waitcnt lgkmcnt(1)
    v_mfma_f32_32x32x16_bf16 v[96:111], v[56:59], v[252:255], v[96:111]
    s_waitcnt lgkmcnt(0)
    v_mfma_f32_32x32x16_bf16 v[112:127], v[60:63], v[252:255], v[112:127]
    v_and_b32 v16, 31, v0
    v_lshlrev_b32 v16, 8, v16
    v_and_b32 v17, 15, v0
    v_lshrrev_b32 v18, 5, v0
    v_xor_b32 v17, v17, v18
    v_lshlrev_b32 v17, 4, v17
    v_add_u32 v8, v16, v17
    v_xor_b32 v9, 32, v8
    v_xor_b32 v10, 64, v8
    v_xor_b32 v11, 96, v8
    v_xor_b32 v12, 128, v8
    v_xor_b32 v13, 160, v8
    v_xor_b32 v14, 192, v8
    v_xor_b32 v15, 224, v8
    v_add_u32 v16, 0x8000, v8
    v_add_u32 v17, 0x8000, v9
    v_add_u32 v18, 0x8000, v10
    v_add_u32 v19, 0x8000, v11
    v_add_u32 v20, 0x8000, v12
    v_add_u32 v21, 0x8000, v13
    v_add_u32 v22, 0x8000, v14
    v_add_u32 v23, 0x8000, v15
    v_mov_b32 v4, 0xff800000
    v_mov_b32 v5, 0xff800000
    v_cvt_pk_bf16_f32 v64, v64, v65
    v_cvt_pk_bf16_f32 v65, v66, v67
    v_cvt_pk_bf16_f32 v66, v68, v69
    v_cvt_pk_bf16_f32 v67, v70, v71
    v_cvt_pk_bf16_f32 v68, v72, v73
    v_cvt_pk_bf16_f32 v69, v74, v75
    v_cvt_pk_bf16_f32 v70, v76, v77
    v_cvt_pk_bf16_f32 v71, v78, v79
    v_cvt_pk_bf16_f32 v72, v80, v81
    v_cvt_pk_bf16_f32 v73, v82, v83
    v_cvt_pk_bf16_f32 v74, v84, v85
    v_cvt_pk_bf16_f32 v75, v86, v87
    v_cvt_pk_bf16_f32 v76, v88, v89
    v_cvt_pk_bf16_f32 v77, v90, v91
    v_cvt_pk_bf16_f32 v78, v92, v93
    v_cvt_pk_bf16_f32 v79, v94, v95
    v_cvt_pk_bf16_f32 v80, v96, v97
    v_cvt_pk_bf16_f32 v81, v98, v99
    v_cvt_pk_bf16_f32 v82, v100, v101
    v_cvt_pk_bf16_f32 v83, v102, v103
    v_cvt_pk_bf16_f32 v84, v104, v105
    v_cvt_pk_bf16_f32 v85, v106, v107
    v_cvt_pk_bf16_f32 v86, v108, v109
    v_cvt_pk_bf16_f32 v87, v110, v111
    v_cvt_pk_bf16_f32 v88, v112, v113
    v_cvt_pk_bf16_f32 v89, v114, v115
    v_cvt_pk_bf16_f32 v90, v116, v117
    v_cvt_pk_bf16_f32 v91, v118, v119
    v_cvt_pk_bf16_f32 v92, v120, v121
    v_cvt_pk_bf16_f32 v93, v122, v123
    v_cvt_pk_bf16_f32 v94, v124, v125
    v_cvt_pk_bf16_f32 v95, v126, v127
    v_permlane32_swap_b32 v64, v66
    v_permlane32_swap_b32 v65, v67
    v_permlane32_swap_b32 v68, v70
    v_permlane32_swap_b32 v69, v71
    v_permlane32_swap_b32 v72, v74
    v_permlane32_swap_b32 v73, v75
    v_permlane32_swap_b32 v76, v78
    v_permlane32_swap_b32 v77, v79
    v_permlane32_swap_b32 v80, v82
    v_permlane32_swap_b32 v81, v83
    v_permlane32_swap_b32 v84, v86
    v_permlane32_swap_b32 v85, v87
    v_permlane32_swap_b32 v88, v90
    v_permlane32_swap_b32 v89, v91
    v_permlane32_swap_b32 v92, v94
    v_permlane32_swap_b32 v93, v95
    s_barrier
    s_add_u32 m0, s65, 16384
    s_add_u32 s62, s61, 65536
    buffer_load_dwordx4 v2, s[44:47], s62 offen offset:0 nt lds
    v_xor_b32 v3, 64, v2
    buffer_load_dwordx4 v3, s[44:47], s62 offen offset:1024 nt lds
    v_xor_b32 v3, 128, v2
    buffer_load_dwordx4 v3, s[44:47], s62 offen offset:2048 nt lds
    v_xor_b32 v3, 192, v2
    buffer_load_dwordx4 v3, s[44:47], s62 offen offset:3072 nt lds
    ds_read_b128 v[32:35], v16 offset:16384
    ds_read_b128 v[36:39], v17 offset:16384
    ds_read_b128 v[40:43], v18 offset:16384
    ds_read_b128 v[44:47], v19 offset:16384
    ds_read_b128 v[48:51], v20 offset:16384
    ds_read_b128 v[52:55], v21 offset:16384
    ds_read_b128 v[56:59], v22 offset:16384
    s_waitcnt lgkmcnt(6)
    v_mfma_f32_32x32x16_bf16 v[96:111], v[32:35], v[64:67], 0
    ds_read_b128 v[60:63], v23 offset:16384
    s_waitcnt lgkmcnt(6)
    v_mfma_f32_32x32x16_bf16 v[96:111], v[36:39], v[68:71], v[96:111]
    ds_read_b128 v[32:35], v16 offset:24576
    s_waitcnt lgkmcnt(6)
    v_mfma_f32_32x32x16_bf16 v[96:111], v[40:43], v[72:75], v[96:111]
    ds_read_b128 v[36:39], v17 offset:24576
    s_waitcnt lgkmcnt(6)
    v_mfma_f32_32x32x16_bf16 v[96:111], v[44:47], v[76:79], v[96:111]
    ds_read_b128 v[40:43], v18 offset:24576
    s_waitcnt lgkmcnt(6)
    v_mfma_f32_32x32x16_bf16 v[96:111], v[48:51], v[80:83], v[96:111]
    ds_read_b128 v[44:47], v19 offset:24576
    s_waitcnt lgkmcnt(6)
    v_mfma_f32_32x32x16_bf16 v[96:111], v[52:55], v[84:87], v[96:111]
    ds_read_b128 v[48:51], v20 offset:24576
    s_waitcnt lgkmcnt(6)
    v_mfma_f32_32x32x16_bf16 v[96:111], v[56:59], v[88:91], v[96:111]
    ds_read_b128 v[52:55], v21 offset:24576
    s_waitcnt lgkmcnt(6)
    v_mfma_f32_32x32x16_bf16 v[96:111], v[60:63], v[92:95], v[96:111]
    ds_read_b128 v[56:59], v22 offset:24576
    s_waitcnt lgkmcnt(6)
    v_mfma_f32_32x32x16_bf16 v[112:127], v[32:35], v[64:67], 0
    ds_read_b128 v[60:63], v23 offset:24576
    s_waitcnt lgkmcnt(6)
    v_mfma_f32_32x32x16_bf16 v[112:127], v[36:39], v[68:71], v[112:127]
    s_barrier
    ds_read_b128 v[32:35], v16 offset:32768
    s_nop 3
    v_max3_f32 v4, v96, v97, v4
    v_cvt_pk_bf16_f32 v128, v96, v97
    v_max3_f32 v5, v98, v99, v5
    s_waitcnt lgkmcnt(6)
    v_mfma_f32_32x32x16_bf16 v[112:127], v[40:43], v[72:75], v[112:127]
    ds_read_b128 v[36:39], v17 offset:32768
    v_cvt_pk_bf16_f32 v129, v98, v99
    v_max3_f32 v4, v100, v101, v4
    v_cvt_pk_bf16_f32 v130, v100, v101
    s_waitcnt lgkmcnt(6)
    v_mfma_f32_32x32x16_bf16 v[112:127], v[44:47], v[76:79], v[112:127]
    ds_read_b128 v[40:43], v18 offset:32768
    v_max3_f32 v5, v102, v103, v5
    v_cvt_pk_bf16_f32 v131, v102, v103
    v_max3_f32 v4, v104, v105, v4
    s_waitcnt lgkmcnt(6)
    v_mfma_f32_32x32x16_bf16 v[112:127], v[48:51], v[80:83], v[112:127]
    ds_read_b128 v[44:47], v19 offset:32768
    v_cvt_pk_bf16_f32 v132, v104, v105
    v_max3_f32 v5, v106, v107, v5
    v_cvt_pk_bf16_f32 v133, v106, v107
    s_waitcnt lgkmcnt(6)
    v_mfma_f32_32x32x16_bf16 v[112:127], v[52:55], v[84:87], v[112:127]
    ds_read_b128 v[48:51], v20 offset:32768
    v_max3_f32 v4, v108, v109, v4
    v_cvt_pk_bf16_f32 v134, v108, v109
    v_max3_f32 v5, v110, v111, v5
    s_waitcnt lgkmcnt(6)
    v_mfma_f32_32x32x16_bf16 v[112:127], v[56:59], v[88:91], v[112:127]
    ds_read_b128 v[52:55], v21 offset:32768
    v_cvt_pk_bf16_f32 v135, v110, v111
    s_waitcnt lgkmcnt(6)
    v_mfma_f32_32x32x16_bf16 v[112:127], v[60:63], v[92:95], v[112:127]
    ds_read_b128 v[56:59], v22 offset:32768
    s_waitcnt lgkmcnt(6)
    v_mfma_f32_32x32x16_bf16 v[96:111], v[32:35], v[64:67], 0
    ds_read_b128 v[60:63], v23 offset:32768
    s_waitcnt lgkmcnt(6)
    v_mfma_f32_32x32x16_bf16 v[96:111], v[36:39], v[68:71], v[96:111]
    ds_read_b128 v[32:35], v16 offset:40960
    s_nop 4
    v_max3_f32 v4, v112, v113, v4
    v_cvt_pk_bf16_f32 v136, v112, v113
    v_max3_f32 v5, v114, v115, v5
    s_waitcnt lgkmcnt(6)
    v_mfma_f32_32x32x16_bf16 v[96:111], v[40:43], v[72:75], v[96:111]
    ds_read_b128 v[36:39], v17 offset:40960
    v_cvt_pk_bf16_f32 v137, v114, v115
    v_max3_f32 v4, v116, v117, v4
    v_cvt_pk_bf16_f32 v138, v116, v117
    s_waitcnt lgkmcnt(6)
    v_mfma_f32_32x32x16_bf16 v[96:111], v[44:47], v[76:79], v[96:111]
    ds_read_b128 v[40:43], v18 offset:40960
    v_max3_f32 v5, v118, v119, v5
    v_cvt_pk_bf16_f32 v139, v118, v119
    v_max3_f32 v4, v120, v121, v4
    s_waitcnt lgkmcnt(6)
    v_mfma_f32_32x32x16_bf16 v[96:111], v[48:51], v[80:83], v[96:111]
    ds_read_b128 v[44:47], v19 offset:40960
    v_cvt_pk_bf16_f32 v140, v120, v121
    v_max3_f32 v5, v122, v123, v5
    v_cvt_pk_bf16_f32 v141, v122, v123
    s_waitcnt lgkmcnt(6)
    v_mfma_f32_32x32x16_bf16 v[96:111], v[52:55], v[84:87], v[96:111]
    ds_read_b128 v[48:51], v20 offset:40960
    v_max3_f32 v4, v124, v125, v4
    v_cvt_pk_bf16_f32 v142, v124, v125
    v_max3_f32 v5, v126, v127, v5
    s_waitcnt lgkmcnt(6)
    v_mfma_f32_32x32x16_bf16 v[96:111], v[56:59], v[88:91], v[96:111]
    ds_read_b128 v[52:55], v21 offset:40960
    v_cvt_pk_bf16_f32 v143, v126, v127
    s_waitcnt lgkmcnt(6)
    v_mfma_f32_32x32x16_bf16 v[96:111], v[60:63], v[92:95], v[96:111]
    ds_read_b128 v[56:59], v22 offset:40960
    s_waitcnt lgkmcnt(6)
    v_mfma_f32_32x32x16_bf16 v[112:127], v[32:35], v[64:67], 0
    ds_read_b128 v[60:63], v23 offset:40960
    s_waitcnt lgkmcnt(6)
    v_mfma_f32_32x32x16_bf16 v[112:127], v[36:39], v[68:71], v[112:127]
    s_waitcnt vmcnt(8)
    s_barrier
    s_add_u32 m0, s65, 49152
    s_add_u32 s62, s61, 81920
    buffer_load_dwordx4 v2, s[44:47], s62 offen offset:0 nt lds
    v_xor_b32 v3, 64, v2
    buffer_load_dwordx4 v3, s[44:47], s62 offen offset:1024 nt lds
    v_xor_b32 v3, 128, v2
    buffer_load_dwordx4 v3, s[44:47], s62 offen offset:2048 nt lds
    v_xor_b32 v3, 192, v2
    buffer_load_dwordx4 v3, s[44:47], s62 offen offset:3072 nt lds
    ds_read_b128 v[32:35], v16 offset:0
    v_max3_f32 v4, v96, v97, v4
    v_cvt_pk_bf16_f32 v144, v96, v97
    v_max3_f32 v5, v98, v99, v5
    s_waitcnt lgkmcnt(6)
    v_mfma_f32_32x32x16_bf16 v[112:127], v[40:43], v[72:75], v[112:127]
    ds_read_b128 v[36:39], v17 offset:0
    v_cvt_pk_bf16_f32 v145, v98, v99
    v_max3_f32 v4, v100, v101, v4
    v_cvt_pk_bf16_f32 v146, v100, v101
    s_waitcnt lgkmcnt(6)
    v_mfma_f32_32x32x16_bf16 v[112:127], v[44:47], v[76:79], v[112:127]
    ds_read_b128 v[40:43], v18 offset:0
    v_max3_f32 v5, v102, v103, v5
    v_cvt_pk_bf16_f32 v147, v102, v103
    v_max3_f32 v4, v104, v105, v4
    s_waitcnt lgkmcnt(6)
    v_mfma_f32_32x32x16_bf16 v[112:127], v[48:51], v[80:83], v[112:127]
    ds_read_b128 v[44:47], v19 offset:0
    v_cvt_pk_bf16_f32 v148, v104, v105
    v_max3_f32 v5, v106, v107, v5
    v_cvt_pk_bf16_f32 v149, v106, v107
    s_waitcnt lgkmcnt(6)
    v_mfma_f32_32x32x16_bf16 v[112:127], v[52:55], v[84:87], v[112:127]
    ds_read_b128 v[48:51], v20 offset:0
    v_max3_f32 v4, v108, v109, v4
    v_cvt_pk_bf16_f32 v150, v108, v109
    v_max3_f32 v5, v110, v111, v5
    s_waitcnt lgkmcnt(6)
    v_mfma_f32_32x32x16_bf16 v[112:127], v[56:59], v[88:91], v[112:127]
    ds_read_b128 v[52:55], v21 offset:0
    v_cvt_pk_bf16_f32 v151, v110, v111
    s_waitcnt lgkmcnt(6)
    v_mfma_f32_32x32x16_bf16 v[112:127], v[60:63], v[92:95], v[112:127]
    ds_read_b128 v[56:59], v22 offset:0
    s_waitcnt lgkmcnt(6)
    v_mfma_f32_32x32x16_bf16 v[96:111], v[32:35], v[64:67], 0
    ds_read_b128 v[60:63], v23 offset:0
    s_waitcnt lgkmcnt(6)
    v_mfma_f32_32x32x16_bf16 v[96:111], v[36:39], v[68:71], v[96:111]
    ds_read_b128 v[32:35], v16 offset:8192
    s_nop 4
    v_max3_f32 v4, v112, v113, v4
    v_cvt_pk_bf16_f32 v152, v112, v113
    v_max3_f32 v5, v114, v115, v5
    s_waitcnt lgkmcnt(6)
    v_mfma_f32_32x32x16_bf16 v[96:111], v[40:43], v[72:75], v[96:111]
    ds_read_b128 v[36:39], v17 offset:8192
    v_cvt_pk_bf16_f32 v153, v114, v115
    v_max3_f32 v4, v116, v117, v4
    v_cvt_pk_bf16_f32 v154, v116, v117
    s_waitcnt lgkmcnt(6)
    v_mfma_f32_32x32x16_bf16 v[96:111], v[44:47], v[76:79], v[96:111]
    ds_read_b128 v[40:43], v18 offset:8192
    v_max3_f32 v5, v118, v119, v5
    v_cvt_pk_bf16_f32 v155, v118, v119
    v_max3_f32 v4, v120, v121, v4
    s_waitcnt lgkmcnt(6)
    v_mfma_f32_32x32x16_bf16 v[96:111], v[48:51], v[80:83], v[96:111]
    ds_read_b128 v[44:47], v19 offset:8192
    v_cvt_pk_bf16_f32 v156, v120, v121
    v_max3_f32 v5, v122, v123, v5
    v_cvt_pk_bf16_f32 v157, v122, v123
    s_waitcnt lgkmcnt(6)
    v_mfma_f32_32x32x16_bf16 v[96:111], v[52:55], v[84:87], v[96:111]
    ds_read_b128 v[48:51], v20 offset:8192
    v_max3_f32 v4, v124, v125, v4
    v_cvt_pk_bf16_f32 v158, v124, v125
    v_max3_f32 v5, v126, v127, v5
    s_waitcnt lgkmcnt(6)
    v_mfma_f32_32x32x16_bf16 v[96:111], v[56:59], v[88:91], v[96:111]
    ds_read_b128 v[52:55], v21 offset:8192
    v_cvt_pk_bf16_f32 v159, v126, v127
    s_waitcnt lgkmcnt(6)
    v_mfma_f32_32x32x16_bf16 v[96:111], v[60:63], v[92:95], v[96:111]
    ds_read_b128 v[56:59], v22 offset:8192
    s_waitcnt lgkmcnt(6)
    v_mfma_f32_32x32x16_bf16 v[112:127], v[32:35], v[64:67], 0
    ds_read_b128 v[60:63], v23 offset:8192
    s_waitcnt lgkmcnt(6)
    v_mfma_f32_32x32x16_bf16 v[112:127], v[36:39], v[68:71], v[112:127]
    s_waitcnt vmcnt(8)
    s_barrier
    s_add_u32 m0, s65, 65536
    s_add_u32 s62, s61, 98304
    buffer_load_dwordx4 v2, s[44:47], s62 offen offset:0 nt lds
    v_xor_b32 v3, 64, v2
    buffer_load_dwordx4 v3, s[44:47], s62 offen offset:1024 nt lds
    v_xor_b32 v3, 128, v2
    buffer_load_dwordx4 v3, s[44:47], s62 offen offset:2048 nt lds
    v_xor_b32 v3, 192, v2
    buffer_load_dwordx4 v3, s[44:47], s62 offen offset:3072 nt lds
    ds_read_b128 v[32:35], v8 offset:0
    v_max3_f32 v4, v96, v97, v4
    v_cvt_pk_bf16_f32 v160, v96, v97
    v_max3_f32 v5, v98, v99, v5
    s_waitcnt lgkmcnt(6)
    v_mfma_f32_32x32x16_bf16 v[112:127], v[40:43], v[72:75], v[112:127]
    ds_read_b128 v[36:39], v9 offset:0
    v_cvt_pk_bf16_f32 v161, v98, v99
    v_max3_f32 v4, v100, v101, v4
    v_cvt_pk_bf16_f32 v162, v100, v101
    s_waitcnt lgkmcnt(6)
    v_mfma_f32_32x32x16_bf16 v[112:127], v[44:47], v[76:79], v[112:127]
    ds_read_b128 v[40:43], v10 offset:0
    v_max3_f32 v5, v102, v103, v5
    v_cvt_pk_bf16_f32 v163, v102, v103
    v_max3_f32 v4, v104, v105, v4
    s_waitcnt lgkmcnt(6)
    v_mfma_f32_32x32x16_bf16 v[112:127], v[48:51], v[80:83], v[112:127]
    ds_read_b128 v[44:47], v11 offset:0
    v_cvt_pk_bf16_f32 v164, v104, v105
    v_max3_f32 v5, v106, v107, v5
    v_cvt_pk_bf16_f32 v165, v106, v107
    s_waitcnt lgkmcnt(6)
    v_mfma_f32_32x32x16_bf16 v[112:127], v[52:55], v[84:87], v[112:127]
    ds_read_b128 v[48:51], v12 offset:0
    v_max3_f32 v4, v108, v109, v4
    v_cvt_pk_bf16_f32 v166, v108, v109
    v_max3_f32 v5, v110, v111, v5
    s_waitcnt lgkmcnt(6)
    v_mfma_f32_32x32x16_bf16 v[112:127], v[56:59], v[88:91], v[112:127]
    ds_read_b128 v[52:55], v13 offset:0
    v_cvt_pk_bf16_f32 v167, v110, v111
    s_waitcnt lgkmcnt(6)
    v_mfma_f32_32x32x16_bf16 v[112:127], v[60:63], v[92:95], v[112:127]
    ds_read_b128 v[56:59], v14 offset:0
    s_waitcnt lgkmcnt(6)
    v_mfma_f32_32x32x16_bf16 v[96:111], v[32:35], v[64:67], 0
    ds_read_b128 v[60:63], v15 offset:0
    s_waitcnt lgkmcnt(6)
    v_mfma_f32_32x32x16_bf16 v[96:111], v[36:39], v[68:71], v[96:111]
    ds_read_b128 v[32:35], v8 offset:8192
    s_nop 4
    v_max3_f32 v4, v112, v113, v4
    v_cvt_pk_bf16_f32 v168, v112, v113
    v_max3_f32 v5, v114, v115, v5
    s_waitcnt lgkmcnt(6)
    v_mfma_f32_32x32x16_bf16 v[96:111], v[40:43], v[72:75], v[96:111]
    ds_read_b128 v[36:39], v9 offset:8192
    v_cvt_pk_bf16_f32 v169, v114, v115
    v_max3_f32 v4, v116, v117, v4
    v_cvt_pk_bf16_f32 v170, v116, v117
    s_waitcnt lgkmcnt(6)
    v_mfma_f32_32x32x16_bf16 v[96:111], v[44:47], v[76:79], v[96:111]
    ds_read_b128 v[40:43], v10 offset:8192
    v_max3_f32 v5, v118, v119, v5
    v_cvt_pk_bf16_f32 v171, v118, v119
    v_max3_f32 v4, v120, v121, v4
    s_waitcnt lgkmcnt(6)
    v_mfma_f32_32x32x16_bf16 v[96:111], v[48:51], v[80:83], v[96:111]
    ds_read_b128 v[44:47], v11 offset:8192
    v_cvt_pk_bf16_f32 v172, v120, v121
    v_max3_f32 v5, v122, v123, v5
    v_cvt_pk_bf16_f32 v173, v122, v123
    s_waitcnt lgkmcnt(6)
    v_mfma_f32_32x32x16_bf16 v[96:111], v[52:55], v[84:87], v[96:111]
    ds_read_b128 v[48:51], v12 offset:8192
    v_max3_f32 v4, v124, v125, v4
    v_cvt_pk_bf16_f32 v174, v124, v125
    v_max3_f32 v5, v126, v127, v5
    s_waitcnt lgkmcnt(6)
    v_mfma_f32_32x32x16_bf16 v[96:111], v[56:59], v[88:91], v[96:111]
    ds_read_b128 v[52:55], v13 offset:8192
    v_cvt_pk_bf16_f32 v175, v126, v127
    s_waitcnt lgkmcnt(6)
    v_mfma_f32_32x32x16_bf16 v[96:111], v[60:63], v[92:95], v[96:111]
    ds_read_b128 v[56:59], v14 offset:8192
    s_waitcnt lgkmcnt(6)
    v_mfma_f32_32x32x16_bf16 v[112:127], v[32:35], v[64:67], 0
    ds_read_b128 v[60:63], v15 offset:8192
    s_waitcnt lgkmcnt(6)
    v_mfma_f32_32x32x16_bf16 v[112:127], v[36:39], v[68:71], v[112:127]
    s_waitcnt vmcnt(8)
    s_barrier
    s_add_u32 m0, s65, 32768
    s_add_u32 s62, s61, 114688
    buffer_load_dwordx4 v2, s[44:47], s62 offen offset:0 nt lds
    v_xor_b32 v3, 64, v2
    buffer_load_dwordx4 v3, s[44:47], s62 offen offset:1024 nt lds
    v_xor_b32 v3, 128, v2
    buffer_load_dwordx4 v3, s[44:47], s62 offen offset:2048 nt lds
    v_xor_b32 v3, 192, v2
    buffer_load_dwordx4 v3, s[44:47], s62 offen offset:3072 nt lds
    ds_read_b128 v[32:35], v8 offset:16384
    v_max3_f32 v4, v96, v97, v4
    v_cvt_pk_bf16_f32 v176, v96, v97
    v_max3_f32 v5, v98, v99, v5
    s_waitcnt lgkmcnt(6)
    v_mfma_f32_32x32x16_bf16 v[112:127], v[40:43], v[72:75], v[112:127]
    ds_read_b128 v[36:39], v9 offset:16384
    v_cvt_pk_bf16_f32 v177, v98, v99
    v_max3_f32 v4, v100, v101, v4
    v_cvt_pk_bf16_f32 v178, v100, v101
    s_waitcnt lgkmcnt(6)
    v_mfma_f32_32x32x16_bf16 v[112:127], v[44:47], v[76:79], v[112:127]
    ds_read_b128 v[40:43], v10 offset:16384
    v_max3_f32 v5, v102, v103, v5
    v_cvt_pk_bf16_f32 v179, v102, v103
    v_max3_f32 v4, v104, v105, v4
    s_waitcnt lgkmcnt(6)
    v_mfma_f32_32x32x16_bf16 v[112:127], v[48:51], v[80:83], v[112:127]
    ds_read_b128 v[44:47], v11 offset:16384
    v_cvt_pk_bf16_f32 v180, v104, v105
    v_max3_f32 v5, v106, v107, v5
    v_cvt_pk_bf16_f32 v181, v106, v107
    s_waitcnt lgkmcnt(6)
    v_mfma_f32_32x32x16_bf16 v[112:127], v[52:55], v[84:87], v[112:127]
    ds_read_b128 v[48:51], v12 offset:16384
    v_max3_f32 v4, v108, v109, v4
    v_cvt_pk_bf16_f32 v182, v108, v109
    v_max3_f32 v5, v110, v111, v5
    s_waitcnt lgkmcnt(6)
    v_mfma_f32_32x32x16_bf16 v[112:127], v[56:59], v[88:91], v[112:127]
    ds_read_b128 v[52:55], v13 offset:16384
    v_cvt_pk_bf16_f32 v183, v110, v111
    s_waitcnt lgkmcnt(6)
    v_mfma_f32_32x32x16_bf16 v[112:127], v[60:63], v[92:95], v[112:127]
    ds_read_b128 v[56:59], v14 offset:16384
    s_waitcnt lgkmcnt(6)
    v_mfma_f32_32x32x16_bf16 v[96:111], v[32:35], v[64:67], 0
    ds_read_b128 v[60:63], v15 offset:16384
    s_waitcnt lgkmcnt(6)
    v_mfma_f32_32x32x16_bf16 v[96:111], v[36:39], v[68:71], v[96:111]
    ds_read_b128 v[32:35], v8 offset:24576
    s_nop 4
    v_max3_f32 v4, v112, v113, v4
    v_cvt_pk_bf16_f32 v184, v112, v113
    v_max3_f32 v5, v114, v115, v5
    s_waitcnt lgkmcnt(6)
    v_mfma_f32_32x32x16_bf16 v[96:111], v[40:43], v[72:75], v[96:111]
    ds_read_b128 v[36:39], v9 offset:24576
    v_cvt_pk_bf16_f32 v185, v114, v115
    v_max3_f32 v4, v116, v117, v4
    v_cvt_pk_bf16_f32 v186, v116, v117
    s_waitcnt lgkmcnt(6)
    v_mfma_f32_32x32x16_bf16 v[96:111], v[44:47], v[76:79], v[96:111]
    ds_read_b128 v[40:43], v10 offset:24576
    v_max3_f32 v5, v118, v119, v5
    v_cvt_pk_bf16_f32 v187, v118, v119
    v_max3_f32 v4, v120, v121, v4
    s_waitcnt lgkmcnt(6)
    v_mfma_f32_32x32x16_bf16 v[96:111], v[48:51], v[80:83], v[96:111]
    ds_read_b128 v[44:47], v11 offset:24576
    v_cvt_pk_bf16_f32 v188, v120, v121
    v_max3_f32 v5, v122, v123, v5
    v_cvt_pk_bf16_f32 v189, v122, v123
    s_waitcnt lgkmcnt(6)
    v_mfma_f32_32x32x16_bf16 v[96:111], v[52:55], v[84:87], v[96:111]
    ds_read_b128 v[48:51], v12 offset:24576
    v_max3_f32 v4, v124, v125, v4
    v_cvt_pk_bf16_f32 v190, v124, v125
    v_max3_f32 v5, v126, v127, v5
    s_waitcnt lgkmcnt(6)
    v_mfma_f32_32x32x16_bf16 v[96:111], v[56:59], v[88:91], v[96:111]
    ds_read_b128 v[52:55], v13 offset:24576
    v_cvt_pk_bf16_f32 v191, v126, v127
    s_waitcnt lgkmcnt(6)
    v_mfma_f32_32x32x16_bf16 v[96:111], v[60:63], v[92:95], v[96:111]
    ds_read_b128 v[56:59], v14 offset:24576
    s_waitcnt lgkmcnt(6)
    v_mfma_f32_32x32x16_bf16 v[112:127], v[32:35], v[64:67], 0
    ds_read_b128 v[60:63], v15 offset:24576
    s_waitcnt lgkmcnt(6)
    v_mfma_f32_32x32x16_bf16 v[112:127], v[36:39], v[68:71], v[112:127]
    s_waitcnt vmcnt(8)
    s_barrier
    s_add_u32 m0, s65, 0
    s_add_u32 s62, s61, 0
    buffer_load_dwordx4 v1, s[48:51], s62 offen offset:0 nt lds
    buffer_load_dwordx4 v1, s[48:51], s62 offen offset:1024 nt lds
    buffer_load_dwordx4 v1, s[48:51], s62 offen offset:2048 nt lds
    buffer_load_dwordx4 v1, s[48:51], s62 offen offset:3072 nt lds
    ds_read_b128 v[32:35], v16 offset:16384
    v_max3_f32 v4, v96, v97, v4
    v_cvt_pk_bf16_f32 v192, v96, v97
    v_max3_f32 v5, v98, v99, v5
    s_waitcnt lgkmcnt(6)
    v_mfma_f32_32x32x16_bf16 v[112:127], v[40:43], v[72:75], v[112:127]
    ds_read_b128 v[36:39], v17 offset:16384
    v_cvt_pk_bf16_f32 v193, v98, v99
    v_max3_f32 v4, v100, v101, v4
    v_cvt_pk_bf16_f32 v194, v100, v101
    s_waitcnt lgkmcnt(6)
    v_mfma_f32_32x32x16_bf16 v[112:127], v[44:47], v[76:79], v[112:127]
    ds_read_b128 v[40:43], v18 offset:16384
    v_max3_f32 v5, v102, v103, v5
    v_cvt_pk_bf16_f32 v195, v102, v103
    v_max3_f32 v4, v104, v105, v4
    s_waitcnt lgkmcnt(6)
    v_mfma_f32_32x32x16_bf16 v[112:127], v[48:51], v[80:83], v[112:127]
    ds_read_b128 v[44:47], v19 offset:16384
    v_cvt_pk_bf16_f32 v196, v104, v105
    v_max3_f32 v5, v106, v107, v5
    v_cvt_pk_bf16_f32 v197, v106, v107
    s_waitcnt lgkmcnt(6)
    v_mfma_f32_32x32x16_bf16 v[112:127], v[52:55], v[84:87], v[112:127]
    ds_read_b128 v[48:51], v20 offset:16384
    v_max3_f32 v4, v108, v109, v4
    v_cvt_pk_bf16_f32 v198, v108, v109
    v_max3_f32 v5, v110, v111, v5
    s_waitcnt lgkmcnt(6)
    v_mfma_f32_32x32x16_bf16 v[112:127], v[56:59], v[88:91], v[112:127]
    ds_read_b128 v[52:55], v21 offset:16384
    v_cvt_pk_bf16_f32 v199, v110, v111
    s_waitcnt lgkmcnt(6)
    v_mfma_f32_32x32x16_bf16 v[112:127], v[60:63], v[92:95], v[112:127]
    ds_read_b128 v[56:59], v22 offset:16384
    s_waitcnt lgkmcnt(6)
    v_mfma_f32_32x32x16_bf16 v[96:111], v[32:35], v[64:67], 0
    ds_read_b128 v[60:63], v23 offset:16384
    s_waitcnt lgkmcnt(6)
    v_mfma_f32_32x32x16_bf16 v[96:111], v[36:39], v[68:71], v[96:111]
    ds_read_b128 v[32:35], v16 offset:24576
    s_nop 4
    v_max3_f32 v4, v112, v113, v4
    v_cvt_pk_bf16_f32 v200, v112, v113
    v_max3_f32 v5, v114, v115, v5
    s_waitcnt lgkmcnt(6)
    v_mfma_f32_32x32x16_bf16 v[96:111], v[40:43], v[72:75], v[96:111]
    ds_read_b128 v[36:39], v17 offset:24576
    v_cvt_pk_bf16_f32 v201, v114, v115
    v_max3_f32 v4, v116, v117, v4
    v_cvt_pk_bf16_f32 v202, v116, v117
    s_waitcnt lgkmcnt(6)
    v_mfma_f32_32x32x16_bf16 v[96:111], v[44:47], v[76:79], v[96:111]
    ds_read_b128 v[40:43], v18 offset:24576
    v_max3_f32 v5, v118, v119, v5
    v_cvt_pk_bf16_f32 v203, v118, v119
    v_max3_f32 v4, v120, v121, v4
    s_waitcnt lgkmcnt(6)
    v_mfma_f32_32x32x16_bf16 v[96:111], v[48:51], v[80:83], v[96:111]
    ds_read_b128 v[44:47], v19 offset:24576
    v_cvt_pk_bf16_f32 v204, v120, v121
    v_max3_f32 v5, v122, v123, v5
    v_cvt_pk_bf16_f32 v205, v122, v123
    s_waitcnt lgkmcnt(6)
    v_mfma_f32_32x32x16_bf16 v[96:111], v[52:55], v[84:87], v[96:111]
    ds_read_b128 v[48:51], v20 offset:24576
    v_max3_f32 v4, v124, v125, v4
    v_cvt_pk_bf16_f32 v206, v124, v125
    v_max3_f32 v5, v126, v127, v5
    s_waitcnt lgkmcnt(6)
    v_mfma_f32_32x32x16_bf16 v[96:111], v[56:59], v[88:91], v[96:111]
    ds_read_b128 v[52:55], v21 offset:24576
    v_cvt_pk_bf16_f32 v207, v126, v127
    s_waitcnt lgkmcnt(6)
    v_mfma_f32_32x32x16_bf16 v[96:111], v[60:63], v[92:95], v[96:111]
    ds_read_b128 v[56:59], v22 offset:24576
    s_waitcnt lgkmcnt(6)
    v_mfma_f32_32x32x16_bf16 v[112:127], v[32:35], v[64:67], 0
    ds_read_b128 v[60:63], v23 offset:24576
    s_waitcnt lgkmcnt(6)
    v_mfma_f32_32x32x16_bf16 v[112:127], v[36:39], v[68:71], v[112:127]
    s_waitcnt vmcnt(8)
    s_barrier
    s_add_u32 m0, s65, 16384
    s_add_u32 s62, s61, 16384
    buffer_load_dwordx4 v1, s[48:51], s62 offen offset:0 nt lds
    buffer_load_dwordx4 v1, s[48:51], s62 offen offset:1024 nt lds
    buffer_load_dwordx4 v1, s[48:51], s62 offen offset:2048 nt lds
    buffer_load_dwordx4 v1, s[48:51], s62 offen offset:3072 nt lds
    ds_read_b128 v[32:35], v16 offset:32768
    v_max3_f32 v4, v96, v97, v4
    v_cvt_pk_bf16_f32 v208, v96, v97
    v_max3_f32 v5, v98, v99, v5
    s_waitcnt lgkmcnt(6)
    v_mfma_f32_32x32x16_bf16 v[112:127], v[40:43], v[72:75], v[112:127]
    ds_read_b128 v[36:39], v17 offset:32768
    v_cvt_pk_bf16_f32 v209, v98, v99
    v_max3_f32 v4, v100, v101, v4
    v_cvt_pk_bf16_f32 v210, v100, v101
    s_waitcnt lgkmcnt(6)
    v_mfma_f32_32x32x16_bf16 v[112:127], v[44:47], v[76:79], v[112:127]
    ds_read_b128 v[40:43], v18 offset:32768
    v_max3_f32 v5, v102, v103, v5
    v_cvt_pk_bf16_f32 v211, v102, v103
    v_max3_f32 v4, v104, v105, v4
    s_waitcnt lgkmcnt(6)
    v_mfma_f32_32x32x16_bf16 v[112:127], v[48:51], v[80:83], v[112:127]
    ds_read_b128 v[44:47], v19 offset:32768
    v_cvt_pk_bf16_f32 v212, v104, v105
    v_max3_f32 v5, v106, v107, v5
    v_cvt_pk_bf16_f32 v213, v106, v107
    s_waitcnt lgkmcnt(6)
    v_mfma_f32_32x32x16_bf16 v[112:127], v[52:55], v[84:87], v[112:127]
    ds_read_b128 v[48:51], v20 offset:32768
    v_max3_f32 v4, v108, v109, v4
    v_cvt_pk_bf16_f32 v214, v108, v109
    v_max3_f32 v5, v110, v111, v5
    s_waitcnt lgkmcnt(6)
    v_mfma_f32_32x32x16_bf16 v[112:127], v[56:59], v[88:91], v[112:127]
    ds_read_b128 v[52:55], v21 offset:32768
    v_cvt_pk_bf16_f32 v215, v110, v111
    s_waitcnt lgkmcnt(6)
    v_mfma_f32_32x32x16_bf16 v[112:127], v[60:63], v[92:95], v[112:127]
    ds_read_b128 v[56:59], v22 offset:32768
    s_waitcnt lgkmcnt(6)
    v_mfma_f32_32x32x16_bf16 v[96:111], v[32:35], v[64:67], 0
    ds_read_b128 v[60:63], v23 offset:32768
    s_waitcnt lgkmcnt(6)
    v_mfma_f32_32x32x16_bf16 v[96:111], v[36:39], v[68:71], v[96:111]
    ds_read_b128 v[32:35], v16 offset:40960
    s_nop 4
    v_max3_f32 v4, v112, v113, v4
    v_cvt_pk_bf16_f32 v216, v112, v113
    v_max3_f32 v5, v114, v115, v5
    s_waitcnt lgkmcnt(6)
    v_mfma_f32_32x32x16_bf16 v[96:111], v[40:43], v[72:75], v[96:111]
    ds_read_b128 v[36:39], v17 offset:40960
    v_cvt_pk_bf16_f32 v217, v114, v115
    v_max3_f32 v4, v116, v117, v4
    v_cvt_pk_bf16_f32 v218, v116, v117
    s_waitcnt lgkmcnt(6)
    v_mfma_f32_32x32x16_bf16 v[96:111], v[44:47], v[76:79], v[96:111]
    ds_read_b128 v[40:43], v18 offset:40960
    v_max3_f32 v5, v118, v119, v5
    v_cvt_pk_bf16_f32 v219, v118, v119
    v_max3_f32 v4, v120, v121, v4
    s_waitcnt lgkmcnt(6)
    v_mfma_f32_32x32x16_bf16 v[96:111], v[48:51], v[80:83], v[96:111]
    ds_read_b128 v[44:47], v19 offset:40960
    v_cvt_pk_bf16_f32 v220, v120, v121
    v_max3_f32 v5, v122, v123, v5
    v_cvt_pk_bf16_f32 v221, v122, v123
    s_waitcnt lgkmcnt(6)
    v_mfma_f32_32x32x16_bf16 v[96:111], v[52:55], v[84:87], v[96:111]
    ds_read_b128 v[48:51], v20 offset:40960
    v_max3_f32 v4, v124, v125, v4
    v_cvt_pk_bf16_f32 v222, v124, v125
    v_max3_f32 v5, v126, v127, v5
    s_waitcnt lgkmcnt(6)
    v_mfma_f32_32x32x16_bf16 v[96:111], v[56:59], v[88:91], v[96:111]
    ds_read_b128 v[52:55], v21 offset:40960
    v_cvt_pk_bf16_f32 v223, v126, v127
    s_waitcnt lgkmcnt(6)
    v_mfma_f32_32x32x16_bf16 v[96:111], v[60:63], v[92:95], v[96:111]
    ds_read_b128 v[56:59], v22 offset:40960
    s_waitcnt lgkmcnt(6)
    v_mfma_f32_32x32x16_bf16 v[112:127], v[32:35], v[64:67], 0
    ds_read_b128 v[60:63], v23 offset:40960
    s_waitcnt lgkmcnt(6)
    v_mfma_f32_32x32x16_bf16 v[112:127], v[36:39], v[68:71], v[112:127]
    s_waitcnt vmcnt(8)
    s_barrier
    s_add_u32 m0, s65, 49152
    s_add_u32 s62, s61, 32768
    buffer_load_dwordx4 v1, s[48:51], s62 offen offset:0 nt lds
    buffer_load_dwordx4 v1, s[48:51], s62 offen offset:1024 nt lds
    buffer_load_dwordx4 v1, s[48:51], s62 offen offset:2048 nt lds
    buffer_load_dwordx4 v1, s[48:51], s62 offen offset:3072 nt lds
    ds_read_b128 v[32:35], v16 offset:0
    v_max3_f32 v4, v96, v97, v4
    v_cvt_pk_bf16_f32 v224, v96, v97
    v_max3_f32 v5, v98, v99, v5
    s_waitcnt lgkmcnt(6)
    v_mfma_f32_32x32x16_bf16 v[112:127], v[40:43], v[72:75], v[112:127]
    ds_read_b128 v[36:39], v17 offset:0
    v_cvt_pk_bf16_f32 v225, v98, v99
    v_max3_f32 v4, v100, v101, v4
    v_cvt_pk_bf16_f32 v226, v100, v101
    s_waitcnt lgkmcnt(6)
    v_mfma_f32_32x32x16_bf16 v[112:127], v[44:47], v[76:79], v[112:127]
    ds_read_b128 v[40:43], v18 offset:0
    v_max3_f32 v5, v102, v103, v5
    v_cvt_pk_bf16_f32 v227, v102, v103
    v_max3_f32 v4, v104, v105, v4
    s_waitcnt lgkmcnt(6)
    v_mfma_f32_32x32x16_bf16 v[112:127], v[48:51], v[80:83], v[112:127]
    ds_read_b128 v[44:47], v19 offset:0
    v_cvt_pk_bf16_f32 v228, v104, v105
    v_max3_f32 v5, v106, v107, v5
    v_cvt_pk_bf16_f32 v229, v106, v107
    s_waitcnt lgkmcnt(6)
    v_mfma_f32_32x32x16_bf16 v[112:127], v[52:55], v[84:87], v[112:127]
    ds_read_b128 v[48:51], v20 offset:0
    v_max3_f32 v4, v108, v109, v4
    v_cvt_pk_bf16_f32 v230, v108, v109
    v_max3_f32 v5, v110, v111, v5
    s_waitcnt lgkmcnt(6)
    v_mfma_f32_32x32x16_bf16 v[112:127], v[56:59], v[88:91], v[112:127]
    ds_read_b128 v[52:55], v21 offset:0
    v_cvt_pk_bf16_f32 v231, v110, v111
    s_waitcnt lgkmcnt(6)
    v_mfma_f32_32x32x16_bf16 v[112:127], v[60:63], v[92:95], v[112:127]
    ds_read_b128 v[56:59], v22 offset:0
    s_waitcnt lgkmcnt(6)
    v_mfma_f32_32x32x16_bf16 v[96:111], v[32:35], v[64:67], 0
    ds_read_b128 v[60:63], v23 offset:0
    s_waitcnt lgkmcnt(6)
    v_mfma_f32_32x32x16_bf16 v[96:111], v[36:39], v[68:71], v[96:111]
    ds_read_b128 v[32:35], v16 offset:8192
    s_nop 4
    v_max3_f32 v4, v112, v113, v4
    v_cvt_pk_bf16_f32 v232, v112, v113
    v_max3_f32 v5, v114, v115, v5
    s_waitcnt lgkmcnt(6)
    v_mfma_f32_32x32x16_bf16 v[96:111], v[40:43], v[72:75], v[96:111]
    ds_read_b128 v[36:39], v17 offset:8192
    v_cvt_pk_bf16_f32 v233, v114, v115
    v_max3_f32 v4, v116, v117, v4
    v_cvt_pk_bf16_f32 v234, v116, v117
    s_waitcnt lgkmcnt(6)
    v_mfma_f32_32x32x16_bf16 v[96:111], v[44:47], v[76:79], v[96:111]
    ds_read_b128 v[40:43], v18 offset:8192
    v_max3_f32 v5, v118, v119, v5
    v_cvt_pk_bf16_f32 v235, v118, v119
    v_max3_f32 v4, v120, v121, v4
    s_waitcnt lgkmcnt(6)
    v_mfma_f32_32x32x16_bf16 v[96:111], v[48:51], v[80:83], v[96:111]
    ds_read_b128 v[44:47], v19 offset:8192
    v_cvt_pk_bf16_f32 v236, v120, v121
    v_max3_f32 v5, v122, v123, v5
    v_cvt_pk_bf16_f32 v237, v122, v123
    s_waitcnt lgkmcnt(6)
    v_mfma_f32_32x32x16_bf16 v[96:111], v[52:55], v[84:87], v[96:111]
    ds_read_b128 v[48:51], v20 offset:8192
    v_max3_f32 v4, v124, v125, v4
    v_cvt_pk_bf16_f32 v238, v124, v125
    v_max3_f32 v5, v126, v127, v5
    s_waitcnt lgkmcnt(6)
    v_mfma_f32_32x32x16_bf16 v[96:111], v[56:59], v[88:91], v[96:111]
    ds_read_b128 v[52:55], v21 offset:8192
    v_cvt_pk_bf16_f32 v239, v126, v127
    s_waitcnt lgkmcnt(6)
    v_mfma_f32_32x32x16_bf16 v[96:111], v[60:63], v[92:95], v[96:111]
    ds_read_b128 v[56:59], v22 offset:8192
    s_waitcnt lgkmcnt(6)
    v_mfma_f32_32x32x16_bf16 v[112:127], v[32:35], v[64:67], 0
    ds_read_b128 v[60:63], v23 offset:8192
    s_waitcnt lgkmcnt(6)
    v_mfma_f32_32x32x16_bf16 v[112:127], v[36:39], v[68:71], v[112:127]
    s_nop 5
    v_max3_f32 v4, v96, v97, v4
    v_cvt_pk_bf16_f32 v240, v96, v97
    v_max3_f32 v5, v98, v99, v5
    s_waitcnt lgkmcnt(5)
    v_mfma_f32_32x32x16_bf16 v[112:127], v[40:43], v[72:75], v[112:127]
    v_cvt_pk_bf16_f32 v241, v98, v99
    v_max3_f32 v4, v100, v101, v4
    v_cvt_pk_bf16_f32 v242, v100, v101
    s_waitcnt lgkmcnt(4)
    v_mfma_f32_32x32x16_bf16 v[112:127], v[44:47], v[76:79], v[112:127]
    v_max3_f32 v5, v102, v103, v5
    v_cvt_pk_bf16_f32 v243, v102, v103
    v_max3_f32 v4, v104, v105, v4
    s_waitcnt lgkmcnt(3)
    v_mfma_f32_32x32x16_bf16 v[112:127], v[48:51], v[80:83], v[112:127]
    v_cvt_pk_bf16_f32 v244, v104, v105
    v_max3_f32 v5, v106, v107, v5
    v_cvt_pk_bf16_f32 v245, v106, v107
    s_waitcnt lgkmcnt(2)
    v_mfma_f32_32x32x16_bf16 v[112:127], v[52:55], v[84:87], v[112:127]
    v_max3_f32 v4, v108, v109, v4
    v_cvt_pk_bf16_f32 v246, v108, v109
    v_max3_f32 v5, v110, v111, v5
    s_waitcnt lgkmcnt(1)
    v_mfma_f32_32x32x16_bf16 v[112:127], v[56:59], v[88:91], v[112:127]
    v_cvt_pk_bf16_f32 v247, v110, v111
    s_waitcnt lgkmcnt(0)
    v_mfma_f32_32x32x16_bf16 v[112:127], v[60:63], v[92:95], v[112:127]
    s_nop 11
    v_max3_f32 v4, v112, v113, v4
    v_cvt_pk_bf16_f32 v248, v112, v113
    v_max3_f32 v5, v114, v115, v5
    v_cvt_pk_bf16_f32 v249, v114, v115
    v_max3_f32 v4, v116, v117, v4
    v_cvt_pk_bf16_f32 v250, v116, v117
    v_max3_f32 v5, v118, v119, v5
    v_cvt_pk_bf16_f32 v251, v118, v119
    v_max3_f32 v4, v120, v121, v4
    v_cvt_pk_bf16_f32 v252, v120, v121
    v_max3_f32 v5, v122, v123, v5
    v_cvt_pk_bf16_f32 v253, v122, v123
    v_max3_f32 v4, v124, v125, v4
    v_cvt_pk_bf16_f32 v254, v124, v125
    v_max3_f32 v5, v126, v127, v5
    v_cvt_pk_bf16_f32 v255, v126, v127
    v_max_f32 v4, v4, v5
    v_mov_b32 v5, v4
    s_nop 1
    v_permlane32_swap_b32 v4, v5
    v_max_f32 v4, v4, v5
    v_cvt_pk_bf16_f32 v5, v4, v4
    v_lshlrev_b32 v5, 16, v5
    v_mul_f32 v4, s66, v5
    v_mov_b32 v5, 0
    v_lshrrev_b32 v16, 2, v0
    v_and_b32 v16, 3, v16
    v_lshrrev_b32 v17, 4, v0
    v_and_b32 v17, 1, v17
    v_and_b32 v18, 3, v0
    v_lshrrev_b32 v19, 5, v0
    v_lshlrev_b32 v19, 10, v19
    v_mul_u32_u24 v20, 0x140, v16
    v_add_u32 v19, v19, v20
    v_lshlrev_b32 v17, 5, v17
    v_add_u32 v19, v19, v17
    v_lshlrev_b32 v18, 3, v18
    v_add_u32 v24, v19, v18
    v_xor_b32 v25, 64, v24
    v_xor_b32 v26, 128, v24
    v_xor_b32 v27, 192, v24
    v_add_u32 v28, 0x8000, v24
    v_add_u32 v29, 0x8000, v25
    v_add_u32 v30, 0x8000, v26
    v_add_u32 v31, 0x8000, v27
    v_lshlrev_b32 v8, 16, v128
    v_and_b32 v9, 0xffff0000, v128
    v_lshlrev_b32 v10, 16, v129
    v_and_b32 v11, 0xffff0000, v129
    v_lshlrev_b32 v12, 16, v130
    v_and_b32 v13, 0xffff0000, v130
    v_lshlrev_b32 v14, 16, v131
    v_and_b32 v15, 0xffff0000, v131
    v_fma_f32 v8, v8, s63, v4
    v_fma_f32 v9, v9, s63, v4
    v_fma_f32 v10, v10, s63, v4
    v_fma_f32 v11, v11, s63, v4
    v_fma_f32 v12, v12, s63, v4
    v_fma_f32 v13, v13, s63, v4
    v_fma_f32 v14, v14, s63, v4
    v_fma_f32 v15, v15, s63, v4
    v_exp_f32 v8, v8
    v_exp_f32 v9, v9
    v_exp_f32 v10, v10
    v_exp_f32 v11, v11
    v_exp_f32 v12, v12
    v_exp_f32 v13, v13
    v_exp_f32 v14, v14
    v_exp_f32 v15, v15
    v_add_f32 v5, v5, v8
    v_cvt_pk_bf16_f32 v16, v8, v9
    v_add_f32 v5, v5, v9
    v_add_f32 v5, v5, v10
    v_cvt_pk_bf16_f32 v17, v10, v11
    v_add_f32 v5, v5, v11
    v_add_f32 v5, v5, v12
    v_cvt_pk_bf16_f32 v18, v12, v13
    v_add_f32 v5, v5, v13
    v_add_f32 v5, v5, v14
    v_cvt_pk_bf16_f32 v19, v14, v15
    v_add_f32 v5, v5, v15
    s_waitcnt vmcnt(8)
    s_barrier
    s_add_u32 m0, s65, 65536
    s_add_u32 s62, s61, 49152
    buffer_load_dwordx4 v1, s[48:51], s62 offen offset:0 nt lds
    buffer_load_dwordx4 v1, s[48:51], s62 offen offset:1024 nt lds
    buffer_load_dwordx4 v1, s[48:51], s62 offen offset:2048 nt lds
    buffer_load_dwordx4 v1, s[48:51], s62 offen offset:3072 nt lds
    s_add_u32 m0, s65, 32768
    s_add_u32 s62, s61, 65536
    buffer_load_dwordx4 v1, s[48:51], s62 offen offset:0 nt lds
    buffer_load_dwordx4 v1, s[48:51], s62 offen offset:1024 nt lds
    buffer_load_dwordx4 v1, s[48:51], s62 offen offset:2048 nt lds
    buffer_load_dwordx4 v1, s[48:51], s62 offen offset:3072 nt lds
    ds_read_b64_tr_b16 v[32:33], v24 offset:0
    ds_read_b64_tr_b16 v[34:35], v24 offset:2048
    ds_read_b64_tr_b16 v[36:37], v25 offset:0
    ds_read_b64_tr_b16 v[38:39], v25 offset:2048
    ds_read_b64_tr_b16 v[40:41], v26 offset:0
    ds_read_b64_tr_b16 v[42:43], v26 offset:2048
    ds_read_b64_tr_b16 v[44:45], v27 offset:0
    ds_read_b64_tr_b16 v[46:47], v27 offset:2048
    ds_read_b64_tr_b16 v[48:49], v24 offset:4096
    ds_read_b64_tr_b16 v[50:51], v24 offset:6144
    ds_read_b64_tr_b16 v[52:53], v25 offset:4096
    ds_read_b64_tr_b16 v[54:55], v25 offset:6144
    ds_read_b64_tr_b16 v[56:57], v26 offset:4096
    ds_read_b64_tr_b16 v[58:59], v26 offset:6144
    v_lshlrev_b32 v8, 16, v132
    v_and_b32 v9, 0xffff0000, v132
    v_lshlrev_b32 v10, 16, v133
    v_and_b32 v11, 0xffff0000, v133
    v_lshlrev_b32 v12, 16, v134
    v_and_b32 v13, 0xffff0000, v134
    v_lshlrev_b32 v14, 16, v135
    v_and_b32 v15, 0xffff0000, v135
    v_fma_f32 v8, v8, s63, v4
    s_waitcnt lgkmcnt(12)
    v_mfma_f32_32x32x16_bf16 v[64:79], v[32:35], v[16:19], 0
    ds_read_b64_tr_b16 v[60:61], v27 offset:4096
    ds_read_b64_tr_b16 v[62:63], v27 offset:6144
    v_fma_f32 v9, v9, s63, v4
    v_fma_f32 v10, v10, s63, v4
    v_fma_f32 v11, v11, s63, v4
    v_fma_f32 v12, v12, s63, v4
    v_fma_f32 v13, v13, s63, v4
    v_fma_f32 v14, v14, s63, v4
    v_fma_f32 v15, v15, s63, v4
    v_exp_f32 v8, v8
    v_exp_f32 v9, v9
    s_waitcnt lgkmcnt(12)
    v_mfma_f32_32x32x16_bf16 v[80:95], v[36:39], v[16:19], 0
    ds_read_b64_tr_b16 v[32:33], v24 offset:8192
    ds_read_b64_tr_b16 v[34:35], v24 offset:10240
    v_exp_f32 v10, v10
    v_exp_f32 v11, v11
    v_exp_f32 v12, v12
    v_exp_f32 v13, v13
    v_exp_f32 v14, v14
    v_exp_f32 v15, v15
    v_add_f32 v5, v5, v8
    v_cvt_pk_bf16_f32 v20, v8, v9
    v_add_f32 v5, v5, v9
    s_waitcnt lgkmcnt(12)
    v_mfma_f32_32x32x16_bf16 v[96:111], v[40:43], v[16:19], 0
    ds_read_b64_tr_b16 v[36:37], v25 offset:8192
    ds_read_b64_tr_b16 v[38:39], v25 offset:10240
    v_add_f32 v5, v5, v10
    v_cvt_pk_bf16_f32 v21, v10, v11
    v_add_f32 v5, v5, v11
    v_add_f32 v5, v5, v12
    v_cvt_pk_bf16_f32 v22, v12, v13
    v_add_f32 v5, v5, v13
    v_add_f32 v5, v5, v14
    v_cvt_pk_bf16_f32 v23, v14, v15
    v_add_f32 v5, v5, v15
    s_waitcnt lgkmcnt(12)
    v_mfma_f32_32x32x16_bf16 v[112:127], v[44:47], v[16:19], 0
    ds_read_b64_tr_b16 v[40:41], v26 offset:8192
    ds_read_b64_tr_b16 v[42:43], v26 offset:10240
    v_lshlrev_b32 v8, 16, v136
    v_and_b32 v9, 0xffff0000, v136
    v_lshlrev_b32 v10, 16, v137
    v_and_b32 v11, 0xffff0000, v137
    v_lshlrev_b32 v12, 16, v138
    v_and_b32 v13, 0xffff0000, v138
    v_lshlrev_b32 v14, 16, v139
    v_and_b32 v15, 0xffff0000, v139
    v_fma_f32 v8, v8, s63, v4
    s_waitcnt lgkmcnt(12)
    v_mfma_f32_32x32x16_bf16 v[64:79], v[48:51], v[20:23], v[64:79]
    ds_read_b64_tr_b16 v[44:45], v27 offset:8192
    ds_read_b64_tr_b16 v[46:47], v27 offset:10240
    v_fma_f32 v9, v9, s63, v4
    v_fma_f32 v10, v10, s63, v4
    v_fma_f32 v11, v11, s63, v4
    v_fma_f32 v12, v12, s63, v4
    v_fma_f32 v13, v13, s63, v4
    v_fma_f32 v14, v14, s63, v4
    v_fma_f32 v15, v15, s63, v4
    v_exp_f32 v8, v8
    v_exp_f32 v9, v9
    s_waitcnt lgkmcnt(12)
    v_mfma_f32_32x32x16_bf16 v[80:95], v[52:55], v[20:23], v[80:95]
    ds_read_b64_tr_b16 v[48:49], v24 offset:12288
    ds_read_b64_tr_b16 v[50:51], v24 offset:14336
    v_exp_f32 v10, v10
    v_exp_f32 v11, v11
    v_exp_f32 v12, v12
    v_exp_f32 v13, v13
    v_exp_f32 v14, v14
    v_exp_f32 v15, v15
    v_add_f32 v5, v5, v8
    v_cvt_pk_bf16_f32 v16, v8, v9
    v_add_f32 v5, v5, v9
    s_waitcnt lgkmcnt(12)
    v_mfma_f32_32x32x16_bf16 v[96:111], v[56:59], v[20:23], v[96:111]
    ds_read_b64_tr_b16 v[52:53], v25 offset:12288
    ds_read_b64_tr_b16 v[54:55], v25 offset:14336
    v_add_f32 v5, v5, v10
    v_cvt_pk_bf16_f32 v17, v10, v11
    v_add_f32 v5, v5, v11
    v_add_f32 v5, v5, v12
    v_cvt_pk_bf16_f32 v18, v12, v13
    v_add_f32 v5, v5, v13
    v_add_f32 v5, v5, v14
    v_cvt_pk_bf16_f32 v19, v14, v15
    v_add_f32 v5, v5, v15
    s_waitcnt lgkmcnt(12)
    v_mfma_f32_32x32x16_bf16 v[112:127], v[60:63], v[20:23], v[112:127]
    ds_read_b64_tr_b16 v[56:57], v26 offset:12288
    ds_read_b64_tr_b16 v[58:59], v26 offset:14336
    v_lshlrev_b32 v8, 16, v140
    v_and_b32 v9, 0xffff0000, v140
    v_lshlrev_b32 v10, 16, v141
    v_and_b32 v11, 0xffff0000, v141
    v_lshlrev_b32 v12, 16, v142
    v_and_b32 v13, 0xffff0000, v142
    v_lshlrev_b32 v14, 16, v143
    v_and_b32 v15, 0xffff0000, v143
    v_fma_f32 v8, v8, s63, v4
    s_waitcnt lgkmcnt(12)
    v_mfma_f32_32x32x16_bf16 v[64:79], v[32:35], v[16:19], v[64:79]
    ds_read_b64_tr_b16 v[60:61], v27 offset:12288
    ds_read_b64_tr_b16 v[62:63], v27 offset:14336
    v_fma_f32 v9, v9, s63, v4
    v_fma_f32 v10, v10, s63, v4
    v_fma_f32 v11, v11, s63, v4
    v_fma_f32 v12, v12, s63, v4
    v_fma_f32 v13, v13, s63, v4
    v_fma_f32 v14, v14, s63, v4
    v_fma_f32 v15, v15, s63, v4
    v_exp_f32 v8, v8
    v_exp_f32 v9, v9
    s_waitcnt lgkmcnt(12)
    v_mfma_f32_32x32x16_bf16 v[80:95], v[36:39], v[16:19], v[80:95]
    s_waitcnt vmcnt(12)
    s_barrier
    ds_read_b64_tr_b16 v[32:33], v24 offset:16384
    ds_read_b64_tr_b16 v[34:35], v24 offset:18432
    v_exp_f32 v10, v10
    v_exp_f32 v11, v11
    v_exp_f32 v12, v12
    v_exp_f32 v13, v13
    v_exp_f32 v14, v14
    v_exp_f32 v15, v15
    v_add_f32 v5, v5, v8
    v_cvt_pk_bf16_f32 v20, v8, v9
    v_add_f32 v5, v5, v9
    s_waitcnt lgkmcnt(12)
    v_mfma_f32_32x32x16_bf16 v[96:111], v[40:43], v[16:19], v[96:111]
    ds_read_b64_tr_b16 v[36:37], v25 offset:16384
    ds_read_b64_tr_b16 v[38:39], v25 offset:18432
    v_add_f32 v5, v5, v10
    v_cvt_pk_bf16_f32 v21, v10, v11
    v_add_f32 v5, v5, v11
    v_add_f32 v5, v5, v12
    v_cvt_pk_bf16_f32 v22, v12, v13
    v_add_f32 v5, v5, v13
    v_add_f32 v5, v5, v14
    v_cvt_pk_bf16_f32 v23, v14, v15
    v_add_f32 v5, v5, v15
    s_waitcnt lgkmcnt(12)
    v_mfma_f32_32x32x16_bf16 v[112:127], v[44:47], v[16:19], v[112:127]
    ds_read_b64_tr_b16 v[40:41], v26 offset:16384
    ds_read_b64_tr_b16 v[42:43], v26 offset:18432
    v_lshlrev_b32 v8, 16, v144
    v_and_b32 v9, 0xffff0000, v144
    v_lshlrev_b32 v10, 16, v145
    v_and_b32 v11, 0xffff0000, v145
    v_lshlrev_b32 v12, 16, v146
    v_and_b32 v13, 0xffff0000, v146
    v_lshlrev_b32 v14, 16, v147
    v_and_b32 v15, 0xffff0000, v147
    v_fma_f32 v8, v8, s63, v4
    s_waitcnt lgkmcnt(12)
    v_mfma_f32_32x32x16_bf16 v[64:79], v[48:51], v[20:23], v[64:79]
    ds_read_b64_tr_b16 v[44:45], v27 offset:16384
    ds_read_b64_tr_b16 v[46:47], v27 offset:18432
    v_fma_f32 v9, v9, s63, v4
    v_fma_f32 v10, v10, s63, v4
    v_fma_f32 v11, v11, s63, v4
    v_fma_f32 v12, v12, s63, v4
    v_fma_f32 v13, v13, s63, v4
    v_fma_f32 v14, v14, s63, v4
    v_fma_f32 v15, v15, s63, v4
    v_exp_f32 v8, v8
    v_exp_f32 v9, v9
    s_waitcnt lgkmcnt(12)
    v_mfma_f32_32x32x16_bf16 v[80:95], v[52:55], v[20:23], v[80:95]
    ds_read_b64_tr_b16 v[48:49], v24 offset:20480
    ds_read_b64_tr_b16 v[50:51], v24 offset:22528
    v_exp_f32 v10, v10
    v_exp_f32 v11, v11
    v_exp_f32 v12, v12
    v_exp_f32 v13, v13
    v_exp_f32 v14, v14
    v_exp_f32 v15, v15
    v_add_f32 v5, v5, v8
    v_cvt_pk_bf16_f32 v16, v8, v9
    v_add_f32 v5, v5, v9
    s_waitcnt lgkmcnt(12)
    v_mfma_f32_32x32x16_bf16 v[96:111], v[56:59], v[20:23], v[96:111]
    ds_read_b64_tr_b16 v[52:53], v25 offset:20480
    ds_read_b64_tr_b16 v[54:55], v25 offset:22528
    v_add_f32 v5, v5, v10
    v_cvt_pk_bf16_f32 v17, v10, v11
    v_add_f32 v5, v5, v11
    v_add_f32 v5, v5, v12
    v_cvt_pk_bf16_f32 v18, v12, v13
    v_add_f32 v5, v5, v13
    v_add_f32 v5, v5, v14
    v_cvt_pk_bf16_f32 v19, v14, v15
    v_add_f32 v5, v5, v15
    s_waitcnt lgkmcnt(12)
    v_mfma_f32_32x32x16_bf16 v[112:127], v[60:63], v[20:23], v[112:127]
    ds_read_b64_tr_b16 v[56:57], v26 offset:20480
    ds_read_b64_tr_b16 v[58:59], v26 offset:22528
    v_lshlrev_b32 v8, 16, v148
    v_and_b32 v9, 0xffff0000, v148
    v_lshlrev_b32 v10, 16, v149
    v_and_b32 v11, 0xffff0000, v149
    v_lshlrev_b32 v12, 16, v150
    v_and_b32 v13, 0xffff0000, v150
    v_lshlrev_b32 v14, 16, v151
    v_and_b32 v15, 0xffff0000, v151
    v_fma_f32 v8, v8, s63, v4
    s_waitcnt lgkmcnt(12)
    v_mfma_f32_32x32x16_bf16 v[64:79], v[32:35], v[16:19], v[64:79]
    ds_read_b64_tr_b16 v[60:61], v27 offset:20480
    ds_read_b64_tr_b16 v[62:63], v27 offset:22528
    v_fma_f32 v9, v9, s63, v4
    v_fma_f32 v10, v10, s63, v4
    v_fma_f32 v11, v11, s63, v4
    v_fma_f32 v12, v12, s63, v4
    v_fma_f32 v13, v13, s63, v4
    v_fma_f32 v14, v14, s63, v4
    v_fma_f32 v15, v15, s63, v4
    v_exp_f32 v8, v8
    v_exp_f32 v9, v9
    s_waitcnt lgkmcnt(12)
    v_mfma_f32_32x32x16_bf16 v[80:95], v[36:39], v[16:19], v[80:95]
    ds_read_b64_tr_b16 v[32:33], v24 offset:24576
    ds_read_b64_tr_b16 v[34:35], v24 offset:26624
    v_exp_f32 v10, v10
    v_exp_f32 v11, v11
    v_exp_f32 v12, v12
    v_exp_f32 v13, v13
    v_exp_f32 v14, v14
    v_exp_f32 v15, v15
    v_add_f32 v5, v5, v8
    v_cvt_pk_bf16_f32 v20, v8, v9
    v_add_f32 v5, v5, v9
    s_waitcnt lgkmcnt(12)
    v_mfma_f32_32x32x16_bf16 v[96:111], v[40:43], v[16:19], v[96:111]
    ds_read_b64_tr_b16 v[36:37], v25 offset:24576
    ds_read_b64_tr_b16 v[38:39], v25 offset:26624
    v_add_f32 v5, v5, v10
    v_cvt_pk_bf16_f32 v21, v10, v11
    v_add_f32 v5, v5, v11
    v_add_f32 v5, v5, v12
    v_cvt_pk_bf16_f32 v22, v12, v13
    v_add_f32 v5, v5, v13
    v_add_f32 v5, v5, v14
    v_cvt_pk_bf16_f32 v23, v14, v15
    v_add_f32 v5, v5, v15
    s_waitcnt lgkmcnt(12)
    v_mfma_f32_32x32x16_bf16 v[112:127], v[44:47], v[16:19], v[112:127]
    ds_read_b64_tr_b16 v[40:41], v26 offset:24576
    ds_read_b64_tr_b16 v[42:43], v26 offset:26624
    v_lshlrev_b32 v8, 16, v152
    v_and_b32 v9, 0xffff0000, v152
    v_lshlrev_b32 v10, 16, v153
    v_and_b32 v11, 0xffff0000, v153
    v_lshlrev_b32 v12, 16, v154
    v_and_b32 v13, 0xffff0000, v154
    v_lshlrev_b32 v14, 16, v155
    v_and_b32 v15, 0xffff0000, v155
    v_fma_f32 v8, v8, s63, v4
    s_waitcnt lgkmcnt(12)
    v_mfma_f32_32x32x16_bf16 v[64:79], v[48:51], v[20:23], v[64:79]
    ds_read_b64_tr_b16 v[44:45], v27 offset:24576
    ds_read_b64_tr_b16 v[46:47], v27 offset:26624
    v_fma_f32 v9, v9, s63, v4
    v_fma_f32 v10, v10, s63, v4
    v_fma_f32 v11, v11, s63, v4
    v_fma_f32 v12, v12, s63, v4
    v_fma_f32 v13, v13, s63, v4
    v_fma_f32 v14, v14, s63, v4
    v_fma_f32 v15, v15, s63, v4
    v_exp_f32 v8, v8
    v_exp_f32 v9, v9
    s_waitcnt lgkmcnt(12)
    v_mfma_f32_32x32x16_bf16 v[80:95], v[52:55], v[20:23], v[80:95]
    ds_read_b64_tr_b16 v[48:49], v24 offset:28672
    ds_read_b64_tr_b16 v[50:51], v24 offset:30720
    v_exp_f32 v10, v10
    v_exp_f32 v11, v11
    v_exp_f32 v12, v12
    v_exp_f32 v13, v13
    v_exp_f32 v14, v14
    v_exp_f32 v15, v15
    v_add_f32 v5, v5, v8
    v_cvt_pk_bf16_f32 v16, v8, v9
    v_add_f32 v5, v5, v9
    s_waitcnt lgkmcnt(12)
    v_mfma_f32_32x32x16_bf16 v[96:111], v[56:59], v[20:23], v[96:111]
    ds_read_b64_tr_b16 v[52:53], v25 offset:28672
    ds_read_b64_tr_b16 v[54:55], v25 offset:30720
    v_add_f32 v5, v5, v10
    v_cvt_pk_bf16_f32 v17, v10, v11
    v_add_f32 v5, v5, v11
    v_add_f32 v5, v5, v12
    v_cvt_pk_bf16_f32 v18, v12, v13
    v_add_f32 v5, v5, v13
    v_add_f32 v5, v5, v14
    v_cvt_pk_bf16_f32 v19, v14, v15
    v_add_f32 v5, v5, v15
    s_waitcnt lgkmcnt(12)
    v_mfma_f32_32x32x16_bf16 v[112:127], v[60:63], v[20:23], v[112:127]
    ds_read_b64_tr_b16 v[56:57], v26 offset:28672
    ds_read_b64_tr_b16 v[58:59], v26 offset:30720
    v_lshlrev_b32 v8, 16, v156
    v_and_b32 v9, 0xffff0000, v156
    v_lshlrev_b32 v10, 16, v157
    v_and_b32 v11, 0xffff0000, v157
    v_lshlrev_b32 v12, 16, v158
    v_and_b32 v13, 0xffff0000, v158
    v_lshlrev_b32 v14, 16, v159
    v_and_b32 v15, 0xffff0000, v159
    v_fma_f32 v8, v8, s63, v4
    s_waitcnt lgkmcnt(12)
    v_mfma_f32_32x32x16_bf16 v[64:79], v[32:35], v[16:19], v[64:79]
    ds_read_b64_tr_b16 v[60:61], v27 offset:28672
    ds_read_b64_tr_b16 v[62:63], v27 offset:30720
    v_fma_f32 v9, v9, s63, v4
    v_fma_f32 v10, v10, s63, v4
    v_fma_f32 v11, v11, s63, v4
    v_fma_f32 v12, v12, s63, v4
    v_fma_f32 v13, v13, s63, v4
    v_fma_f32 v14, v14, s63, v4
    v_fma_f32 v15, v15, s63, v4
    v_exp_f32 v8, v8
    v_exp_f32 v9, v9
    s_waitcnt lgkmcnt(12)
    v_mfma_f32_32x32x16_bf16 v[80:95], v[36:39], v[16:19], v[80:95]
    s_waitcnt vmcnt(8)
    s_barrier
    s_add_u32 m0, s65, 0
    s_add_u32 s62, s61, 81920
    buffer_load_dwordx4 v1, s[48:51], s62 offen offset:0 nt lds
    buffer_load_dwordx4 v1, s[48:51], s62 offen offset:1024 nt lds
    buffer_load_dwordx4 v1, s[48:51], s62 offen offset:2048 nt lds
    buffer_load_dwordx4 v1, s[48:51], s62 offen offset:3072 nt lds
    ds_read_b64_tr_b16 v[32:33], v28 offset:16384
    ds_read_b64_tr_b16 v[34:35], v28 offset:18432
    v_exp_f32 v10, v10
    v_exp_f32 v11, v11
    v_exp_f32 v12, v12
    v_exp_f32 v13, v13
    v_exp_f32 v14, v14
    v_exp_f32 v15, v15
    v_add_f32 v5, v5, v8
    v_cvt_pk_bf16_f32 v20, v8, v9
    v_add_f32 v5, v5, v9
    s_waitcnt lgkmcnt(12)
    v_mfma_f32_32x32x16_bf16 v[96:111], v[40:43], v[16:19], v[96:111]
    ds_read_b64_tr_b16 v[36:37], v29 offset:16384
    ds_read_b64_tr_b16 v[38:39], v29 offset:18432
    v_add_f32 v5, v5, v10
    v_cvt_pk_bf16_f32 v21, v10, v11
    v_add_f32 v5, v5, v11
    v_add_f32 v5, v5, v12
    v_cvt_pk_bf16_f32 v22, v12, v13
    v_add_f32 v5, v5, v13
    v_add_f32 v5, v5, v14
    v_cvt_pk_bf16_f32 v23, v14, v15
    v_add_f32 v5, v5, v15
    s_waitcnt lgkmcnt(12)
    v_mfma_f32_32x32x16_bf16 v[112:127], v[44:47], v[16:19], v[112:127]
    ds_read_b64_tr_b16 v[40:41], v30 offset:16384
    ds_read_b64_tr_b16 v[42:43], v30 offset:18432
    v_lshlrev_b32 v8, 16, v160
    v_and_b32 v9, 0xffff0000, v160
    v_lshlrev_b32 v10, 16, v161
    v_and_b32 v11, 0xffff0000, v161
    v_lshlrev_b32 v12, 16, v162
    v_and_b32 v13, 0xffff0000, v162
    v_lshlrev_b32 v14, 16, v163
    v_and_b32 v15, 0xffff0000, v163
    v_fma_f32 v8, v8, s63, v4
    s_waitcnt lgkmcnt(12)
    v_mfma_f32_32x32x16_bf16 v[64:79], v[48:51], v[20:23], v[64:79]
    ds_read_b64_tr_b16 v[44:45], v31 offset:16384
    ds_read_b64_tr_b16 v[46:47], v31 offset:18432
    v_fma_f32 v9, v9, s63, v4
    v_fma_f32 v10, v10, s63, v4
    v_fma_f32 v11, v11, s63, v4
    v_fma_f32 v12, v12, s63, v4
    v_fma_f32 v13, v13, s63, v4
    v_fma_f32 v14, v14, s63, v4
    v_fma_f32 v15, v15, s63, v4
    v_exp_f32 v8, v8
    v_exp_f32 v9, v9
    s_waitcnt lgkmcnt(12)
    v_mfma_f32_32x32x16_bf16 v[80:95], v[52:55], v[20:23], v[80:95]
    ds_read_b64_tr_b16 v[48:49], v28 offset:20480
    ds_read_b64_tr_b16 v[50:51], v28 offset:22528
    v_exp_f32 v10, v10
    v_exp_f32 v11, v11
    v_exp_f32 v12, v12
    v_exp_f32 v13, v13
    v_exp_f32 v14, v14
    v_exp_f32 v15, v15
    v_add_f32 v5, v5, v8
    v_cvt_pk_bf16_f32 v16, v8, v9
    v_add_f32 v5, v5, v9
    s_waitcnt lgkmcnt(12)
    v_mfma_f32_32x32x16_bf16 v[96:111], v[56:59], v[20:23], v[96:111]
    ds_read_b64_tr_b16 v[52:53], v29 offset:20480
    ds_read_b64_tr_b16 v[54:55], v29 offset:22528
    v_add_f32 v5, v5, v10
    v_cvt_pk_bf16_f32 v17, v10, v11
    v_add_f32 v5, v5, v11
    v_add_f32 v5, v5, v12
    v_cvt_pk_bf16_f32 v18, v12, v13
    v_add_f32 v5, v5, v13
    v_add_f32 v5, v5, v14
    v_cvt_pk_bf16_f32 v19, v14, v15
    v_add_f32 v5, v5, v15
    s_waitcnt lgkmcnt(12)
    v_mfma_f32_32x32x16_bf16 v[112:127], v[60:63], v[20:23], v[112:127]
    ds_read_b64_tr_b16 v[56:57], v30 offset:20480
    ds_read_b64_tr_b16 v[58:59], v30 offset:22528
    v_lshlrev_b32 v8, 16, v164
    v_and_b32 v9, 0xffff0000, v164
    v_lshlrev_b32 v10, 16, v165
    v_and_b32 v11, 0xffff0000, v165
    v_lshlrev_b32 v12, 16, v166
    v_and_b32 v13, 0xffff0000, v166
    v_lshlrev_b32 v14, 16, v167
    v_and_b32 v15, 0xffff0000, v167
    v_fma_f32 v8, v8, s63, v4
    s_waitcnt lgkmcnt(12)
    v_mfma_f32_32x32x16_bf16 v[64:79], v[32:35], v[16:19], v[64:79]
    ds_read_b64_tr_b16 v[60:61], v31 offset:20480
    ds_read_b64_tr_b16 v[62:63], v31 offset:22528
    v_fma_f32 v9, v9, s63, v4
    v_fma_f32 v10, v10, s63, v4
    v_fma_f32 v11, v11, s63, v4
    v_fma_f32 v12, v12, s63, v4
    v_fma_f32 v13, v13, s63, v4
    v_fma_f32 v14, v14, s63, v4
    v_fma_f32 v15, v15, s63, v4
    v_exp_f32 v8, v8
    v_exp_f32 v9, v9
    s_waitcnt lgkmcnt(12)
    v_mfma_f32_32x32x16_bf16 v[80:95], v[36:39], v[16:19], v[80:95]
    ds_read_b64_tr_b16 v[32:33], v28 offset:24576
    ds_read_b64_tr_b16 v[34:35], v28 offset:26624
    v_exp_f32 v10, v10
    v_exp_f32 v11, v11
    v_exp_f32 v12, v12
    v_exp_f32 v13, v13
    v_exp_f32 v14, v14
    v_exp_f32 v15, v15
    v_add_f32 v5, v5, v8
    v_cvt_pk_bf16_f32 v20, v8, v9
    v_add_f32 v5, v5, v9
    s_waitcnt lgkmcnt(12)
    v_mfma_f32_32x32x16_bf16 v[96:111], v[40:43], v[16:19], v[96:111]
    ds_read_b64_tr_b16 v[36:37], v29 offset:24576
    ds_read_b64_tr_b16 v[38:39], v29 offset:26624
    v_add_f32 v5, v5, v10
    v_cvt_pk_bf16_f32 v21, v10, v11
    v_add_f32 v5, v5, v11
    v_add_f32 v5, v5, v12
    v_cvt_pk_bf16_f32 v22, v12, v13
    v_add_f32 v5, v5, v13
    v_add_f32 v5, v5, v14
    v_cvt_pk_bf16_f32 v23, v14, v15
    v_add_f32 v5, v5, v15
    s_waitcnt lgkmcnt(12)
    v_mfma_f32_32x32x16_bf16 v[112:127], v[44:47], v[16:19], v[112:127]
    ds_read_b64_tr_b16 v[40:41], v30 offset:24576
    ds_read_b64_tr_b16 v[42:43], v30 offset:26624
    v_lshlrev_b32 v8, 16, v168
    v_and_b32 v9, 0xffff0000, v168
    v_lshlrev_b32 v10, 16, v169
    v_and_b32 v11, 0xffff0000, v169
    v_lshlrev_b32 v12, 16, v170
    v_and_b32 v13, 0xffff0000, v170
    v_lshlrev_b32 v14, 16, v171
    v_and_b32 v15, 0xffff0000, v171
    v_fma_f32 v8, v8, s63, v4
    s_waitcnt lgkmcnt(12)
    v_mfma_f32_32x32x16_bf16 v[64:79], v[48:51], v[20:23], v[64:79]
    ds_read_b64_tr_b16 v[44:45], v31 offset:24576
    ds_read_b64_tr_b16 v[46:47], v31 offset:26624
    v_fma_f32 v9, v9, s63, v4
    v_fma_f32 v10, v10, s63, v4
    v_fma_f32 v11, v11, s63, v4
    v_fma_f32 v12, v12, s63, v4
    v_fma_f32 v13, v13, s63, v4
    v_fma_f32 v14, v14, s63, v4
    v_fma_f32 v15, v15, s63, v4
    v_exp_f32 v8, v8
    v_exp_f32 v9, v9
    s_waitcnt lgkmcnt(12)
    v_mfma_f32_32x32x16_bf16 v[80:95], v[52:55], v[20:23], v[80:95]
    ds_read_b64_tr_b16 v[48:49], v28 offset:28672
    ds_read_b64_tr_b16 v[50:51], v28 offset:30720
    v_exp_f32 v10, v10
    v_exp_f32 v11, v11
    v_exp_f32 v12, v12
    v_exp_f32 v13, v13
    v_exp_f32 v14, v14
    v_exp_f32 v15, v15
    v_add_f32 v5, v5, v8
    v_cvt_pk_bf16_f32 v16, v8, v9
    v_add_f32 v5, v5, v9
    s_waitcnt lgkmcnt(12)
    v_mfma_f32_32x32x16_bf16 v[96:111], v[56:59], v[20:23], v[96:111]
    ds_read_b64_tr_b16 v[52:53], v29 offset:28672
    ds_read_b64_tr_b16 v[54:55], v29 offset:30720
    v_add_f32 v5, v5, v10
    v_cvt_pk_bf16_f32 v17, v10, v11
    v_add_f32 v5, v5, v11
    v_add_f32 v5, v5, v12
    v_cvt_pk_bf16_f32 v18, v12, v13
    v_add_f32 v5, v5, v13
    v_add_f32 v5, v5, v14
    v_cvt_pk_bf16_f32 v19, v14, v15
    v_add_f32 v5, v5, v15
    s_waitcnt lgkmcnt(12)
    v_mfma_f32_32x32x16_bf16 v[112:127], v[60:63], v[20:23], v[112:127]
    ds_read_b64_tr_b16 v[56:57], v30 offset:28672
    ds_read_b64_tr_b16 v[58:59], v30 offset:30720
    v_lshlrev_b32 v8, 16, v172
    v_and_b32 v9, 0xffff0000, v172
    v_lshlrev_b32 v10, 16, v173
    v_and_b32 v11, 0xffff0000, v173
    v_lshlrev_b32 v12, 16, v174
    v_and_b32 v13, 0xffff0000, v174
    v_lshlrev_b32 v14, 16, v175
    v_and_b32 v15, 0xffff0000, v175
    v_fma_f32 v8, v8, s63, v4
    s_waitcnt lgkmcnt(12)
    v_mfma_f32_32x32x16_bf16 v[64:79], v[32:35], v[16:19], v[64:79]
    ds_read_b64_tr_b16 v[60:61], v31 offset:28672
    ds_read_b64_tr_b16 v[62:63], v31 offset:30720
    v_fma_f32 v9, v9, s63, v4
    v_fma_f32 v10, v10, s63, v4
    v_fma_f32 v11, v11, s63, v4
    v_fma_f32 v12, v12, s63, v4
    v_fma_f32 v13, v13, s63, v4
    v_fma_f32 v14, v14, s63, v4
    v_fma_f32 v15, v15, s63, v4
    v_exp_f32 v8, v8
    v_exp_f32 v9, v9
    s_waitcnt lgkmcnt(12)
    v_mfma_f32_32x32x16_bf16 v[80:95], v[36:39], v[16:19], v[80:95]
    s_waitcnt vmcnt(8)
    s_barrier
    s_add_u32 m0, s65, 16384
    s_add_u32 s62, s61, 98304
    buffer_load_dwordx4 v1, s[48:51], s62 offen offset:0 nt lds
    buffer_load_dwordx4 v1, s[48:51], s62 offen offset:1024 nt lds
    buffer_load_dwordx4 v1, s[48:51], s62 offen offset:2048 nt lds
    buffer_load_dwordx4 v1, s[48:51], s62 offen offset:3072 nt lds
    ds_read_b64_tr_b16 v[32:33], v28 offset:32768
    ds_read_b64_tr_b16 v[34:35], v28 offset:34816
    v_exp_f32 v10, v10
    v_exp_f32 v11, v11
    v_exp_f32 v12, v12
    v_exp_f32 v13, v13
    v_exp_f32 v14, v14
    v_exp_f32 v15, v15
    v_add_f32 v5, v5, v8
    v_cvt_pk_bf16_f32 v20, v8, v9
    v_add_f32 v5, v5, v9
    s_waitcnt lgkmcnt(12)
    v_mfma_f32_32x32x16_bf16 v[96:111], v[40:43], v[16:19], v[96:111]
    ds_read_b64_tr_b16 v[36:37], v29 offset:32768
    ds_read_b64_tr_b16 v[38:39], v29 offset:34816
    v_add_f32 v5, v5, v10
    v_cvt_pk_bf16_f32 v21, v10, v11
    v_add_f32 v5, v5, v11
    v_add_f32 v5, v5, v12
    v_cvt_pk_bf16_f32 v22, v12, v13
    v_add_f32 v5, v5, v13
    v_add_f32 v5, v5, v14
    v_cvt_pk_bf16_f32 v23, v14, v15
    v_add_f32 v5, v5, v15
    s_waitcnt lgkmcnt(12)
    v_mfma_f32_32x32x16_bf16 v[112:127], v[44:47], v[16:19], v[112:127]
    ds_read_b64_tr_b16 v[40:41], v30 offset:32768
    ds_read_b64_tr_b16 v[42:43], v30 offset:34816
    v_lshlrev_b32 v8, 16, v176
    v_and_b32 v9, 0xffff0000, v176
    v_lshlrev_b32 v10, 16, v177
    v_and_b32 v11, 0xffff0000, v177
    v_lshlrev_b32 v12, 16, v178
    v_and_b32 v13, 0xffff0000, v178
    v_lshlrev_b32 v14, 16, v179
    v_and_b32 v15, 0xffff0000, v179
    v_fma_f32 v8, v8, s63, v4
    s_waitcnt lgkmcnt(12)
    v_mfma_f32_32x32x16_bf16 v[64:79], v[48:51], v[20:23], v[64:79]
    ds_read_b64_tr_b16 v[44:45], v31 offset:32768
    ds_read_b64_tr_b16 v[46:47], v31 offset:34816
    v_fma_f32 v9, v9, s63, v4
    v_fma_f32 v10, v10, s63, v4
    v_fma_f32 v11, v11, s63, v4
    v_fma_f32 v12, v12, s63, v4
    v_fma_f32 v13, v13, s63, v4
    v_fma_f32 v14, v14, s63, v4
    v_fma_f32 v15, v15, s63, v4
    v_exp_f32 v8, v8
    v_exp_f32 v9, v9
    s_waitcnt lgkmcnt(12)
    v_mfma_f32_32x32x16_bf16 v[80:95], v[52:55], v[20:23], v[80:95]
    ds_read_b64_tr_b16 v[48:49], v28 offset:36864
    ds_read_b64_tr_b16 v[50:51], v28 offset:38912
    v_exp_f32 v10, v10
    v_exp_f32 v11, v11
    v_exp_f32 v12, v12
    v_exp_f32 v13, v13
    v_exp_f32 v14, v14
    v_exp_f32 v15, v15
    v_add_f32 v5, v5, v8
    v_cvt_pk_bf16_f32 v16, v8, v9
    v_add_f32 v5, v5, v9
    s_waitcnt lgkmcnt(12)
    v_mfma_f32_32x32x16_bf16 v[96:111], v[56:59], v[20:23], v[96:111]
    ds_read_b64_tr_b16 v[52:53], v29 offset:36864
    ds_read_b64_tr_b16 v[54:55], v29 offset:38912
    v_add_f32 v5, v5, v10
    v_cvt_pk_bf16_f32 v17, v10, v11
    v_add_f32 v5, v5, v11
    v_add_f32 v5, v5, v12
    v_cvt_pk_bf16_f32 v18, v12, v13
    v_add_f32 v5, v5, v13
    v_add_f32 v5, v5, v14
    v_cvt_pk_bf16_f32 v19, v14, v15
    v_add_f32 v5, v5, v15
    s_waitcnt lgkmcnt(12)
    v_mfma_f32_32x32x16_bf16 v[112:127], v[60:63], v[20:23], v[112:127]
    ds_read_b64_tr_b16 v[56:57], v30 offset:36864
    ds_read_b64_tr_b16 v[58:59], v30 offset:38912
    v_lshlrev_b32 v8, 16, v180
    v_and_b32 v9, 0xffff0000, v180
    v_lshlrev_b32 v10, 16, v181
    v_and_b32 v11, 0xffff0000, v181
    v_lshlrev_b32 v12, 16, v182
    v_and_b32 v13, 0xffff0000, v182
    v_lshlrev_b32 v14, 16, v183
    v_and_b32 v15, 0xffff0000, v183
    v_fma_f32 v8, v8, s63, v4
    s_waitcnt lgkmcnt(12)
    v_mfma_f32_32x32x16_bf16 v[64:79], v[32:35], v[16:19], v[64:79]
    ds_read_b64_tr_b16 v[60:61], v31 offset:36864
    ds_read_b64_tr_b16 v[62:63], v31 offset:38912
    v_fma_f32 v9, v9, s63, v4
    v_fma_f32 v10, v10, s63, v4
    v_fma_f32 v11, v11, s63, v4
    v_fma_f32 v12, v12, s63, v4
    v_fma_f32 v13, v13, s63, v4
    v_fma_f32 v14, v14, s63, v4
    v_fma_f32 v15, v15, s63, v4
    v_exp_f32 v8, v8
    v_exp_f32 v9, v9
    s_waitcnt lgkmcnt(12)
    v_mfma_f32_32x32x16_bf16 v[80:95], v[36:39], v[16:19], v[80:95]
    ds_read_b64_tr_b16 v[32:33], v28 offset:40960
    ds_read_b64_tr_b16 v[34:35], v28 offset:43008
    v_exp_f32 v10, v10
    v_exp_f32 v11, v11
    v_exp_f32 v12, v12
    v_exp_f32 v13, v13
    v_exp_f32 v14, v14
    v_exp_f32 v15, v15
    v_add_f32 v5, v5, v8
    v_cvt_pk_bf16_f32 v20, v8, v9
    v_add_f32 v5, v5, v9
    s_waitcnt lgkmcnt(12)
    v_mfma_f32_32x32x16_bf16 v[96:111], v[40:43], v[16:19], v[96:111]
    ds_read_b64_tr_b16 v[36:37], v29 offset:40960
    ds_read_b64_tr_b16 v[38:39], v29 offset:43008
    v_add_f32 v5, v5, v10
    v_cvt_pk_bf16_f32 v21, v10, v11
    v_add_f32 v5, v5, v11
    v_add_f32 v5, v5, v12
    v_cvt_pk_bf16_f32 v22, v12, v13
    v_add_f32 v5, v5, v13
    v_add_f32 v5, v5, v14
    v_cvt_pk_bf16_f32 v23, v14, v15
    v_add_f32 v5, v5, v15
    s_waitcnt lgkmcnt(12)
    v_mfma_f32_32x32x16_bf16 v[112:127], v[44:47], v[16:19], v[112:127]
    ds_read_b64_tr_b16 v[40:41], v30 offset:40960
    ds_read_b64_tr_b16 v[42:43], v30 offset:43008
    v_lshlrev_b32 v8, 16, v184
    v_and_b32 v9, 0xffff0000, v184
    v_lshlrev_b32 v10, 16, v185
    v_and_b32 v11, 0xffff0000, v185
    v_lshlrev_b32 v12, 16, v186
    v_and_b32 v13, 0xffff0000, v186
    v_lshlrev_b32 v14, 16, v187
    v_and_b32 v15, 0xffff0000, v187
    v_fma_f32 v8, v8, s63, v4
    s_waitcnt lgkmcnt(12)
    v_mfma_f32_32x32x16_bf16 v[64:79], v[48:51], v[20:23], v[64:79]
    ds_read_b64_tr_b16 v[44:45], v31 offset:40960
    ds_read_b64_tr_b16 v[46:47], v31 offset:43008
    v_fma_f32 v9, v9, s63, v4
    v_fma_f32 v10, v10, s63, v4
    v_fma_f32 v11, v11, s63, v4
    v_fma_f32 v12, v12, s63, v4
    v_fma_f32 v13, v13, s63, v4
    v_fma_f32 v14, v14, s63, v4
    v_fma_f32 v15, v15, s63, v4
    v_exp_f32 v8, v8
    v_exp_f32 v9, v9
    s_waitcnt lgkmcnt(12)
    v_mfma_f32_32x32x16_bf16 v[80:95], v[52:55], v[20:23], v[80:95]
    ds_read_b64_tr_b16 v[48:49], v28 offset:45056
    ds_read_b64_tr_b16 v[50:51], v28 offset:47104
    v_exp_f32 v10, v10
    v_exp_f32 v11, v11
    v_exp_f32 v12, v12
    v_exp_f32 v13, v13
    v_exp_f32 v14, v14
    v_exp_f32 v15, v15
    v_add_f32 v5, v5, v8
    v_cvt_pk_bf16_f32 v16, v8, v9
    v_add_f32 v5, v5, v9
    s_waitcnt lgkmcnt(12)
    v_mfma_f32_32x32x16_bf16 v[96:111], v[56:59], v[20:23], v[96:111]
    ds_read_b64_tr_b16 v[52:53], v29 offset:45056
    ds_read_b64_tr_b16 v[54:55], v29 offset:47104
    v_add_f32 v5, v5, v10
    v_cvt_pk_bf16_f32 v17, v10, v11
    v_add_f32 v5, v5, v11
    v_add_f32 v5, v5, v12
    v_cvt_pk_bf16_f32 v18, v12, v13
    v_add_f32 v5, v5, v13
    v_add_f32 v5, v5, v14
    v_cvt_pk_bf16_f32 v19, v14, v15
    v_add_f32 v5, v5, v15
    s_waitcnt lgkmcnt(12)
    v_mfma_f32_32x32x16_bf16 v[112:127], v[60:63], v[20:23], v[112:127]
    ds_read_b64_tr_b16 v[56:57], v30 offset:45056
    ds_read_b64_tr_b16 v[58:59], v30 offset:47104
    v_lshlrev_b32 v8, 16, v188
    v_and_b32 v9, 0xffff0000, v188
    v_lshlrev_b32 v10, 16, v189
    v_and_b32 v11, 0xffff0000, v189
    v_lshlrev_b32 v12, 16, v190
    v_and_b32 v13, 0xffff0000, v190
    v_lshlrev_b32 v14, 16, v191
    v_and_b32 v15, 0xffff0000, v191
    v_fma_f32 v8, v8, s63, v4
    s_waitcnt lgkmcnt(12)
    v_mfma_f32_32x32x16_bf16 v[64:79], v[32:35], v[16:19], v[64:79]
    ds_read_b64_tr_b16 v[60:61], v31 offset:45056
    ds_read_b64_tr_b16 v[62:63], v31 offset:47104
    v_fma_f32 v9, v9, s63, v4
    v_fma_f32 v10, v10, s63, v4
    v_fma_f32 v11, v11, s63, v4
    v_fma_f32 v12, v12, s63, v4
    v_fma_f32 v13, v13, s63, v4
    v_fma_f32 v14, v14, s63, v4
    v_fma_f32 v15, v15, s63, v4
    v_exp_f32 v8, v8
    v_exp_f32 v9, v9
    s_waitcnt lgkmcnt(12)
    v_mfma_f32_32x32x16_bf16 v[80:95], v[36:39], v[16:19], v[80:95]
    s_waitcnt vmcnt(8)
    s_barrier
    s_add_u32 m0, s65, 49152
    s_add_u32 s62, s61, 114688
    buffer_load_dwordx4 v1, s[48:51], s62 offen offset:0 nt lds
    buffer_load_dwordx4 v1, s[48:51], s62 offen offset:1024 nt lds
    buffer_load_dwordx4 v1, s[48:51], s62 offen offset:2048 nt lds
    buffer_load_dwordx4 v1, s[48:51], s62 offen offset:3072 nt lds
    ds_read_b64_tr_b16 v[32:33], v28 offset:0
    ds_read_b64_tr_b16 v[34:35], v28 offset:2048
    v_exp_f32 v10, v10
    v_exp_f32 v11, v11
    v_exp_f32 v12, v12
    v_exp_f32 v13, v13
    v_exp_f32 v14, v14
    v_exp_f32 v15, v15
    v_add_f32 v5, v5, v8
    v_cvt_pk_bf16_f32 v20, v8, v9
    v_add_f32 v5, v5, v9
    s_waitcnt lgkmcnt(12)
    v_mfma_f32_32x32x16_bf16 v[96:111], v[40:43], v[16:19], v[96:111]
    ds_read_b64_tr_b16 v[36:37], v29 offset:0
    ds_read_b64_tr_b16 v[38:39], v29 offset:2048
    v_add_f32 v5, v5, v10
    v_cvt_pk_bf16_f32 v21, v10, v11
    v_add_f32 v5, v5, v11
    v_add_f32 v5, v5, v12
    v_cvt_pk_bf16_f32 v22, v12, v13
    v_add_f32 v5, v5, v13
    v_add_f32 v5, v5, v14
    v_cvt_pk_bf16_f32 v23, v14, v15
    v_add_f32 v5, v5, v15
    s_waitcnt lgkmcnt(12)
    v_mfma_f32_32x32x16_bf16 v[112:127], v[44:47], v[16:19], v[112:127]
    ds_read_b64_tr_b16 v[40:41], v30 offset:0
    ds_read_b64_tr_b16 v[42:43], v30 offset:2048
    v_lshlrev_b32 v8, 16, v192
    v_and_b32 v9, 0xffff0000, v192
    v_lshlrev_b32 v10, 16, v193
    v_and_b32 v11, 0xffff0000, v193
    v_lshlrev_b32 v12, 16, v194
    v_and_b32 v13, 0xffff0000, v194
    v_lshlrev_b32 v14, 16, v195
    v_and_b32 v15, 0xffff0000, v195
    v_fma_f32 v8, v8, s63, v4
    s_waitcnt lgkmcnt(12)
    v_mfma_f32_32x32x16_bf16 v[64:79], v[48:51], v[20:23], v[64:79]
    ds_read_b64_tr_b16 v[44:45], v31 offset:0
    ds_read_b64_tr_b16 v[46:47], v31 offset:2048
    v_fma_f32 v9, v9, s63, v4
    v_fma_f32 v10, v10, s63, v4
    v_fma_f32 v11, v11, s63, v4
    v_fma_f32 v12, v12, s63, v4
    v_fma_f32 v13, v13, s63, v4
    v_fma_f32 v14, v14, s63, v4
    v_fma_f32 v15, v15, s63, v4
    v_exp_f32 v8, v8
    v_exp_f32 v9, v9
    s_waitcnt lgkmcnt(12)
    v_mfma_f32_32x32x16_bf16 v[80:95], v[52:55], v[20:23], v[80:95]
    ds_read_b64_tr_b16 v[48:49], v28 offset:4096
    ds_read_b64_tr_b16 v[50:51], v28 offset:6144
    v_exp_f32 v10, v10
    v_exp_f32 v11, v11
    v_exp_f32 v12, v12
    v_exp_f32 v13, v13
    v_exp_f32 v14, v14
    v_exp_f32 v15, v15
    v_add_f32 v5, v5, v8
    v_cvt_pk_bf16_f32 v16, v8, v9
    v_add_f32 v5, v5, v9
    s_waitcnt lgkmcnt(12)
    v_mfma_f32_32x32x16_bf16 v[96:111], v[56:59], v[20:23], v[96:111]
    ds_read_b64_tr_b16 v[52:53], v29 offset:4096
    ds_read_b64_tr_b16 v[54:55], v29 offset:6144
    v_add_f32 v5, v5, v10
    v_cvt_pk_bf16_f32 v17, v10, v11
    v_add_f32 v5, v5, v11
    v_add_f32 v5, v5, v12
    v_cvt_pk_bf16_f32 v18, v12, v13
    v_add_f32 v5, v5, v13
    v_add_f32 v5, v5, v14
    v_cvt_pk_bf16_f32 v19, v14, v15
    v_add_f32 v5, v5, v15
    s_waitcnt lgkmcnt(12)
    v_mfma_f32_32x32x16_bf16 v[112:127], v[60:63], v[20:23], v[112:127]
    ds_read_b64_tr_b16 v[56:57], v30 offset:4096
    ds_read_b64_tr_b16 v[58:59], v30 offset:6144
    v_lshlrev_b32 v8, 16, v196
    v_and_b32 v9, 0xffff0000, v196
    v_lshlrev_b32 v10, 16, v197
    v_and_b32 v11, 0xffff0000, v197
    v_lshlrev_b32 v12, 16, v198
    v_and_b32 v13, 0xffff0000, v198
    v_lshlrev_b32 v14, 16, v199
    v_and_b32 v15, 0xffff0000, v199
    v_fma_f32 v8, v8, s63, v4
    s_waitcnt lgkmcnt(12)
    v_mfma_f32_32x32x16_bf16 v[64:79], v[32:35], v[16:19], v[64:79]
    ds_read_b64_tr_b16 v[60:61], v31 offset:4096
    ds_read_b64_tr_b16 v[62:63], v31 offset:6144
    v_fma_f32 v9, v9, s63, v4
    v_fma_f32 v10, v10, s63, v4
    v_fma_f32 v11, v11, s63, v4
    v_fma_f32 v12, v12, s63, v4
    v_fma_f32 v13, v13, s63, v4
    v_fma_f32 v14, v14, s63, v4
    v_fma_f32 v15, v15, s63, v4
    v_exp_f32 v8, v8
    v_exp_f32 v9, v9
    s_waitcnt lgkmcnt(12)
    v_mfma_f32_32x32x16_bf16 v[80:95], v[36:39], v[16:19], v[80:95]
    ds_read_b64_tr_b16 v[32:33], v28 offset:8192
    ds_read_b64_tr_b16 v[34:35], v28 offset:10240
    v_exp_f32 v10, v10
    v_exp_f32 v11, v11
    v_exp_f32 v12, v12
    v_exp_f32 v13, v13
    v_exp_f32 v14, v14
    v_exp_f32 v15, v15
    v_add_f32 v5, v5, v8
    v_cvt_pk_bf16_f32 v20, v8, v9
    v_add_f32 v5, v5, v9
    s_waitcnt lgkmcnt(12)
    v_mfma_f32_32x32x16_bf16 v[96:111], v[40:43], v[16:19], v[96:111]
    ds_read_b64_tr_b16 v[36:37], v29 offset:8192
    ds_read_b64_tr_b16 v[38:39], v29 offset:10240
    v_add_f32 v5, v5, v10
    v_cvt_pk_bf16_f32 v21, v10, v11
    v_add_f32 v5, v5, v11
    v_add_f32 v5, v5, v12
    v_cvt_pk_bf16_f32 v22, v12, v13
    v_add_f32 v5, v5, v13
    v_add_f32 v5, v5, v14
    v_cvt_pk_bf16_f32 v23, v14, v15
    v_add_f32 v5, v5, v15
    s_waitcnt lgkmcnt(12)
    v_mfma_f32_32x32x16_bf16 v[112:127], v[44:47], v[16:19], v[112:127]
    ds_read_b64_tr_b16 v[40:41], v30 offset:8192
    ds_read_b64_tr_b16 v[42:43], v30 offset:10240
    v_lshlrev_b32 v8, 16, v200
    v_and_b32 v9, 0xffff0000, v200
    v_lshlrev_b32 v10, 16, v201
    v_and_b32 v11, 0xffff0000, v201
    v_lshlrev_b32 v12, 16, v202
    v_and_b32 v13, 0xffff0000, v202
    v_lshlrev_b32 v14, 16, v203
    v_and_b32 v15, 0xffff0000, v203
    v_fma_f32 v8, v8, s63, v4
    s_waitcnt lgkmcnt(12)
    v_mfma_f32_32x32x16_bf16 v[64:79], v[48:51], v[20:23], v[64:79]
    ds_read_b64_tr_b16 v[44:45], v31 offset:8192
    ds_read_b64_tr_b16 v[46:47], v31 offset:10240
    v_fma_f32 v9, v9, s63, v4
    v_fma_f32 v10, v10, s63, v4
    v_fma_f32 v11, v11, s63, v4
    v_fma_f32 v12, v12, s63, v4
    v_fma_f32 v13, v13, s63, v4
    v_fma_f32 v14, v14, s63, v4
    v_fma_f32 v15, v15, s63, v4
    v_exp_f32 v8, v8
    v_exp_f32 v9, v9
    s_waitcnt lgkmcnt(12)
    v_mfma_f32_32x32x16_bf16 v[80:95], v[52:55], v[20:23], v[80:95]
    ds_read_b64_tr_b16 v[48:49], v28 offset:12288
    ds_read_b64_tr_b16 v[50:51], v28 offset:14336
    v_exp_f32 v10, v10
    v_exp_f32 v11, v11
    v_exp_f32 v12, v12
    v_exp_f32 v13, v13
    v_exp_f32 v14, v14
    v_exp_f32 v15, v15
    v_add_f32 v5, v5, v8
    v_cvt_pk_bf16_f32 v16, v8, v9
    v_add_f32 v5, v5, v9
    s_waitcnt lgkmcnt(12)
    v_mfma_f32_32x32x16_bf16 v[96:111], v[56:59], v[20:23], v[96:111]
    ds_read_b64_tr_b16 v[52:53], v29 offset:12288
    ds_read_b64_tr_b16 v[54:55], v29 offset:14336
    v_add_f32 v5, v5, v10
    v_cvt_pk_bf16_f32 v17, v10, v11
    v_add_f32 v5, v5, v11
    v_add_f32 v5, v5, v12
    v_cvt_pk_bf16_f32 v18, v12, v13
    v_add_f32 v5, v5, v13
    v_add_f32 v5, v5, v14
    v_cvt_pk_bf16_f32 v19, v14, v15
    v_add_f32 v5, v5, v15
    s_waitcnt lgkmcnt(12)
    v_mfma_f32_32x32x16_bf16 v[112:127], v[60:63], v[20:23], v[112:127]
    ds_read_b64_tr_b16 v[56:57], v30 offset:12288
    ds_read_b64_tr_b16 v[58:59], v30 offset:14336
    v_lshlrev_b32 v8, 16, v204
    v_and_b32 v9, 0xffff0000, v204
    v_lshlrev_b32 v10, 16, v205
    v_and_b32 v11, 0xffff0000, v205
    v_lshlrev_b32 v12, 16, v206
    v_and_b32 v13, 0xffff0000, v206
    v_lshlrev_b32 v14, 16, v207
    v_and_b32 v15, 0xffff0000, v207
    v_fma_f32 v8, v8, s63, v4
    s_waitcnt lgkmcnt(12)
    v_mfma_f32_32x32x16_bf16 v[64:79], v[32:35], v[16:19], v[64:79]
    ds_read_b64_tr_b16 v[60:61], v31 offset:12288
    ds_read_b64_tr_b16 v[62:63], v31 offset:14336
    v_fma_f32 v9, v9, s63, v4
    v_fma_f32 v10, v10, s63, v4
    v_fma_f32 v11, v11, s63, v4
    v_fma_f32 v12, v12, s63, v4
    v_fma_f32 v13, v13, s63, v4
    v_fma_f32 v14, v14, s63, v4
    v_fma_f32 v15, v15, s63, v4
    v_exp_f32 v8, v8
    v_exp_f32 v9, v9
    s_waitcnt lgkmcnt(12)
    v_mfma_f32_32x32x16_bf16 v[80:95], v[36:39], v[16:19], v[80:95]
    s_waitcnt vmcnt(8)
    s_barrier
    ds_read_b64_tr_b16 v[32:33], v24 offset:0
    ds_read_b64_tr_b16 v[34:35], v24 offset:2048
    v_exp_f32 v10, v10
    v_exp_f32 v11, v11
    v_exp_f32 v12, v12
    v_exp_f32 v13, v13
    v_exp_f32 v14, v14
    v_exp_f32 v15, v15
    v_add_f32 v5, v5, v8
    v_cvt_pk_bf16_f32 v20, v8, v9
    v_add_f32 v5, v5, v9
    s_waitcnt lgkmcnt(12)
    v_mfma_f32_32x32x16_bf16 v[96:111], v[40:43], v[16:19], v[96:111]
    ds_read_b64_tr_b16 v[36:37], v25 offset:0
    ds_read_b64_tr_b16 v[38:39], v25 offset:2048
    v_add_f32 v5, v5, v10
    v_cvt_pk_bf16_f32 v21, v10, v11
    v_add_f32 v5, v5, v11
    v_add_f32 v5, v5, v12
    v_cvt_pk_bf16_f32 v22, v12, v13
    v_add_f32 v5, v5, v13
    v_add_f32 v5, v5, v14
    v_cvt_pk_bf16_f32 v23, v14, v15
    v_add_f32 v5, v5, v15
    s_waitcnt lgkmcnt(12)
    v_mfma_f32_32x32x16_bf16 v[112:127], v[44:47], v[16:19], v[112:127]
    ds_read_b64_tr_b16 v[40:41], v26 offset:0
    ds_read_b64_tr_b16 v[42:43], v26 offset:2048
    v_lshlrev_b32 v8, 16, v208
    v_and_b32 v9, 0xffff0000, v208
    v_lshlrev_b32 v10, 16, v209
    v_and_b32 v11, 0xffff0000, v209
    v_lshlrev_b32 v12, 16, v210
    v_and_b32 v13, 0xffff0000, v210
    v_lshlrev_b32 v14, 16, v211
    v_and_b32 v15, 0xffff0000, v211
    v_fma_f32 v8, v8, s63, v4
    s_waitcnt lgkmcnt(12)
    v_mfma_f32_32x32x16_bf16 v[64:79], v[48:51], v[20:23], v[64:79]
    ds_read_b64_tr_b16 v[44:45], v27 offset:0
    ds_read_b64_tr_b16 v[46:47], v27 offset:2048
    v_fma_f32 v9, v9, s63, v4
    v_fma_f32 v10, v10, s63, v4
    v_fma_f32 v11, v11, s63, v4
    v_fma_f32 v12, v12, s63, v4
    v_fma_f32 v13, v13, s63, v4
    v_fma_f32 v14, v14, s63, v4
    v_fma_f32 v15, v15, s63, v4
    v_exp_f32 v8, v8
    v_exp_f32 v9, v9
    s_waitcnt lgkmcnt(12)
    v_mfma_f32_32x32x16_bf16 v[80:95], v[52:55], v[20:23], v[80:95]
    ds_read_b64_tr_b16 v[48:49], v24 offset:4096
    ds_read_b64_tr_b16 v[50:51], v24 offset:6144
    v_exp_f32 v10, v10
    v_exp_f32 v11, v11
    v_exp_f32 v12, v12
    v_exp_f32 v13, v13
    v_exp_f32 v14, v14
    v_exp_f32 v15, v15
    v_add_f32 v5, v5, v8
    v_cvt_pk_bf16_f32 v16, v8, v9
    v_add_f32 v5, v5, v9
    s_waitcnt lgkmcnt(12)
    v_mfma_f32_32x32x16_bf16 v[96:111], v[56:59], v[20:23], v[96:111]
    ds_read_b64_tr_b16 v[52:53], v25 offset:4096
    ds_read_b64_tr_b16 v[54:55], v25 offset:6144
    v_add_f32 v5, v5, v10
    v_cvt_pk_bf16_f32 v17, v10, v11
    v_add_f32 v5, v5, v11
    v_add_f32 v5, v5, v12
    v_cvt_pk_bf16_f32 v18, v12, v13
    v_add_f32 v5, v5, v13
    v_add_f32 v5, v5, v14
    v_cvt_pk_bf16_f32 v19, v14, v15
    v_add_f32 v5, v5, v15
    s_waitcnt lgkmcnt(12)
    v_mfma_f32_32x32x16_bf16 v[112:127], v[60:63], v[20:23], v[112:127]
    ds_read_b64_tr_b16 v[56:57], v26 offset:4096
    ds_read_b64_tr_b16 v[58:59], v26 offset:6144
    v_lshlrev_b32 v8, 16, v212
    v_and_b32 v9, 0xffff0000, v212
    v_lshlrev_b32 v10, 16, v213
    v_and_b32 v11, 0xffff0000, v213
    v_lshlrev_b32 v12, 16, v214
    v_and_b32 v13, 0xffff0000, v214
    v_lshlrev_b32 v14, 16, v215
    v_and_b32 v15, 0xffff0000, v215
    v_fma_f32 v8, v8, s63, v4
    s_waitcnt lgkmcnt(12)
    v_mfma_f32_32x32x16_bf16 v[64:79], v[32:35], v[16:19], v[64:79]
    ds_read_b64_tr_b16 v[60:61], v27 offset:4096
    ds_read_b64_tr_b16 v[62:63], v27 offset:6144
    v_fma_f32 v9, v9, s63, v4
    v_fma_f32 v10, v10, s63, v4
    v_fma_f32 v11, v11, s63, v4
    v_fma_f32 v12, v12, s63, v4
    v_fma_f32 v13, v13, s63, v4
    v_fma_f32 v14, v14, s63, v4
    v_fma_f32 v15, v15, s63, v4
    v_exp_f32 v8, v8
    v_exp_f32 v9, v9
    s_waitcnt lgkmcnt(12)
    v_mfma_f32_32x32x16_bf16 v[80:95], v[36:39], v[16:19], v[80:95]
    ds_read_b64_tr_b16 v[32:33], v24 offset:8192
    ds_read_b64_tr_b16 v[34:35], v24 offset:10240
    v_exp_f32 v10, v10
    v_exp_f32 v11, v11
    v_exp_f32 v12, v12
    v_exp_f32 v13, v13
    v_exp_f32 v14, v14
    v_exp_f32 v15, v15
    v_add_f32 v5, v5, v8
    v_cvt_pk_bf16_f32 v20, v8, v9
    v_add_f32 v5, v5, v9
    s_waitcnt lgkmcnt(12)
    v_mfma_f32_32x32x16_bf16 v[96:111], v[40:43], v[16:19], v[96:111]
    ds_read_b64_tr_b16 v[36:37], v25 offset:8192
    ds_read_b64_tr_b16 v[38:39], v25 offset:10240
    v_add_f32 v5, v5, v10
    v_cvt_pk_bf16_f32 v21, v10, v11
    v_add_f32 v5, v5, v11
    v_add_f32 v5, v5, v12
    v_cvt_pk_bf16_f32 v22, v12, v13
    v_add_f32 v5, v5, v13
    v_add_f32 v5, v5, v14
    v_cvt_pk_bf16_f32 v23, v14, v15
    v_add_f32 v5, v5, v15
    s_waitcnt lgkmcnt(12)
    v_mfma_f32_32x32x16_bf16 v[112:127], v[44:47], v[16:19], v[112:127]
    ds_read_b64_tr_b16 v[40:41], v26 offset:8192
    ds_read_b64_tr_b16 v[42:43], v26 offset:10240
    v_lshlrev_b32 v8, 16, v216
    v_and_b32 v9, 0xffff0000, v216
    v_lshlrev_b32 v10, 16, v217
    v_and_b32 v11, 0xffff0000, v217
    v_lshlrev_b32 v12, 16, v218
    v_and_b32 v13, 0xffff0000, v218
    v_lshlrev_b32 v14, 16, v219
    v_and_b32 v15, 0xffff0000, v219
    v_fma_f32 v8, v8, s63, v4
    s_waitcnt lgkmcnt(12)
    v_mfma_f32_32x32x16_bf16 v[64:79], v[48:51], v[20:23], v[64:79]
    ds_read_b64_tr_b16 v[44:45], v27 offset:8192
    ds_read_b64_tr_b16 v[46:47], v27 offset:10240
    v_fma_f32 v9, v9, s63, v4
    v_fma_f32 v10, v10, s63, v4
    v_fma_f32 v11, v11, s63, v4
    v_fma_f32 v12, v12, s63, v4
    v_fma_f32 v13, v13, s63, v4
    v_fma_f32 v14, v14, s63, v4
    v_fma_f32 v15, v15, s63, v4
    v_exp_f32 v8, v8
    v_exp_f32 v9, v9
    s_waitcnt lgkmcnt(12)
    v_mfma_f32_32x32x16_bf16 v[80:95], v[52:55], v[20:23], v[80:95]
    ds_read_b64_tr_b16 v[48:49], v24 offset:12288
    ds_read_b64_tr_b16 v[50:51], v24 offset:14336
    v_exp_f32 v10, v10
    v_exp_f32 v11, v11
    v_exp_f32 v12, v12
    v_exp_f32 v13, v13
    v_exp_f32 v14, v14
    v_exp_f32 v15, v15
    v_add_f32 v5, v5, v8
    v_cvt_pk_bf16_f32 v16, v8, v9
    v_add_f32 v5, v5, v9
    s_waitcnt lgkmcnt(12)
    v_mfma_f32_32x32x16_bf16 v[96:111], v[56:59], v[20:23], v[96:111]
    ds_read_b64_tr_b16 v[52:53], v25 offset:12288
    ds_read_b64_tr_b16 v[54:55], v25 offset:14336
    v_add_f32 v5, v5, v10
    v_cvt_pk_bf16_f32 v17, v10, v11
    v_add_f32 v5, v5, v11
    v_add_f32 v5, v5, v12
    v_cvt_pk_bf16_f32 v18, v12, v13
    v_add_f32 v5, v5, v13
    v_add_f32 v5, v5, v14
    v_cvt_pk_bf16_f32 v19, v14, v15
    v_add_f32 v5, v5, v15
    s_waitcnt lgkmcnt(12)
    v_mfma_f32_32x32x16_bf16 v[112:127], v[60:63], v[20:23], v[112:127]
    ds_read_b64_tr_b16 v[56:57], v26 offset:12288
    ds_read_b64_tr_b16 v[58:59], v26 offset:14336
    v_lshlrev_b32 v8, 16, v220
    v_and_b32 v9, 0xffff0000, v220
    v_lshlrev_b32 v10, 16, v221
    v_and_b32 v11, 0xffff0000, v221
    v_lshlrev_b32 v12, 16, v222
    v_and_b32 v13, 0xffff0000, v222
    v_lshlrev_b32 v14, 16, v223
    v_and_b32 v15, 0xffff0000, v223
    v_fma_f32 v8, v8, s63, v4
    s_waitcnt lgkmcnt(12)
    v_mfma_f32_32x32x16_bf16 v[64:79], v[32:35], v[16:19], v[64:79]
    ds_read_b64_tr_b16 v[60:61], v27 offset:12288
    ds_read_b64_tr_b16 v[62:63], v27 offset:14336
    v_fma_f32 v9, v9, s63, v4
    v_fma_f32 v10, v10, s63, v4
    v_fma_f32 v11, v11, s63, v4
    v_fma_f32 v12, v12, s63, v4
    v_fma_f32 v13, v13, s63, v4
    v_fma_f32 v14, v14, s63, v4
    v_fma_f32 v15, v15, s63, v4
    v_exp_f32 v8, v8
    v_exp_f32 v9, v9
    s_waitcnt lgkmcnt(12)
    v_mfma_f32_32x32x16_bf16 v[80:95], v[36:39], v[16:19], v[80:95]
    s_waitcnt vmcnt(4)
    s_barrier
    ds_read_b64_tr_b16 v[32:33], v24 offset:16384
    ds_read_b64_tr_b16 v[34:35], v24 offset:18432
    v_exp_f32 v10, v10
    v_exp_f32 v11, v11
    v_exp_f32 v12, v12
    v_exp_f32 v13, v13
    v_exp_f32 v14, v14
    v_exp_f32 v15, v15
    v_add_f32 v5, v5, v8
    v_cvt_pk_bf16_f32 v20, v8, v9
    v_add_f32 v5, v5, v9
    s_waitcnt lgkmcnt(12)
    v_mfma_f32_32x32x16_bf16 v[96:111], v[40:43], v[16:19], v[96:111]
    ds_read_b64_tr_b16 v[36:37], v25 offset:16384
    ds_read_b64_tr_b16 v[38:39], v25 offset:18432
    v_add_f32 v5, v5, v10
    v_cvt_pk_bf16_f32 v21, v10, v11
    v_add_f32 v5, v5, v11
    v_add_f32 v5, v5, v12
    v_cvt_pk_bf16_f32 v22, v12, v13
    v_add_f32 v5, v5, v13
    v_add_f32 v5, v5, v14
    v_cvt_pk_bf16_f32 v23, v14, v15
    v_add_f32 v5, v5, v15
    s_waitcnt lgkmcnt(12)
    v_mfma_f32_32x32x16_bf16 v[112:127], v[44:47], v[16:19], v[112:127]
    ds_read_b64_tr_b16 v[40:41], v26 offset:16384
    ds_read_b64_tr_b16 v[42:43], v26 offset:18432
    v_lshlrev_b32 v8, 16, v224
    v_and_b32 v9, 0xffff0000, v224
    v_lshlrev_b32 v10, 16, v225
    v_and_b32 v11, 0xffff0000, v225
    v_lshlrev_b32 v12, 16, v226
    v_and_b32 v13, 0xffff0000, v226
    v_lshlrev_b32 v14, 16, v227
    v_and_b32 v15, 0xffff0000, v227
    v_fma_f32 v8, v8, s63, v4
    s_waitcnt lgkmcnt(12)
    v_mfma_f32_32x32x16_bf16 v[64:79], v[48:51], v[20:23], v[64:79]
    ds_read_b64_tr_b16 v[44:45], v27 offset:16384
    ds_read_b64_tr_b16 v[46:47], v27 offset:18432
    v_fma_f32 v9, v9, s63, v4
    v_fma_f32 v10, v10, s63, v4
    v_fma_f32 v11, v11, s63, v4
    v_fma_f32 v12, v12, s63, v4
    v_fma_f32 v13, v13, s63, v4
    v_fma_f32 v14, v14, s63, v4
    v_fma_f32 v15, v15, s63, v4
    v_exp_f32 v8, v8
    v_exp_f32 v9, v9
    s_waitcnt lgkmcnt(12)
    v_mfma_f32_32x32x16_bf16 v[80:95], v[52:55], v[20:23], v[80:95]
    ds_read_b64_tr_b16 v[48:49], v24 offset:20480
    ds_read_b64_tr_b16 v[50:51], v24 offset:22528
    v_exp_f32 v10, v10
    v_exp_f32 v11, v11
    v_exp_f32 v12, v12
    v_exp_f32 v13, v13
    v_exp_f32 v14, v14
    v_exp_f32 v15, v15
    v_add_f32 v5, v5, v8
    v_cvt_pk_bf16_f32 v16, v8, v9
    v_add_f32 v5, v5, v9
    s_waitcnt lgkmcnt(12)
    v_mfma_f32_32x32x16_bf16 v[96:111], v[56:59], v[20:23], v[96:111]
    ds_read_b64_tr_b16 v[52:53], v25 offset:20480
    ds_read_b64_tr_b16 v[54:55], v25 offset:22528
    v_add_f32 v5, v5, v10
    v_cvt_pk_bf16_f32 v17, v10, v11
    v_add_f32 v5, v5, v11
    v_add_f32 v5, v5, v12
    v_cvt_pk_bf16_f32 v18, v12, v13
    v_add_f32 v5, v5, v13
    v_add_f32 v5, v5, v14
    v_cvt_pk_bf16_f32 v19, v14, v15
    v_add_f32 v5, v5, v15
    s_waitcnt lgkmcnt(12)
    v_mfma_f32_32x32x16_bf16 v[112:127], v[60:63], v[20:23], v[112:127]
    ds_read_b64_tr_b16 v[56:57], v26 offset:20480
    ds_read_b64_tr_b16 v[58:59], v26 offset:22528
    v_lshlrev_b32 v8, 16, v228
    v_and_b32 v9, 0xffff0000, v228
    v_lshlrev_b32 v10, 16, v229
    v_and_b32 v11, 0xffff0000, v229
    v_lshlrev_b32 v12, 16, v230
    v_and_b32 v13, 0xffff0000, v230
    v_lshlrev_b32 v14, 16, v231
    v_and_b32 v15, 0xffff0000, v231
    v_fma_f32 v8, v8, s63, v4
    s_waitcnt lgkmcnt(12)
    v_mfma_f32_32x32x16_bf16 v[64:79], v[32:35], v[16:19], v[64:79]
    ds_read_b64_tr_b16 v[60:61], v27 offset:20480
    ds_read_b64_tr_b16 v[62:63], v27 offset:22528
    v_fma_f32 v9, v9, s63, v4
    v_fma_f32 v10, v10, s63, v4
    v_fma_f32 v11, v11, s63, v4
    v_fma_f32 v12, v12, s63, v4
    v_fma_f32 v13, v13, s63, v4
    v_fma_f32 v14, v14, s63, v4
    v_fma_f32 v15, v15, s63, v4
    v_exp_f32 v8, v8
    v_exp_f32 v9, v9
    s_waitcnt lgkmcnt(12)
    v_mfma_f32_32x32x16_bf16 v[80:95], v[36:39], v[16:19], v[80:95]
    ds_read_b64_tr_b16 v[32:33], v24 offset:24576
    ds_read_b64_tr_b16 v[34:35], v24 offset:26624
    v_exp_f32 v10, v10
    v_exp_f32 v11, v11
    v_exp_f32 v12, v12
    v_exp_f32 v13, v13
    v_exp_f32 v14, v14
    v_exp_f32 v15, v15
    v_add_f32 v5, v5, v8
    v_cvt_pk_bf16_f32 v20, v8, v9
    v_add_f32 v5, v5, v9
    s_waitcnt lgkmcnt(12)
    v_mfma_f32_32x32x16_bf16 v[96:111], v[40:43], v[16:19], v[96:111]
    ds_read_b64_tr_b16 v[36:37], v25 offset:24576
    ds_read_b64_tr_b16 v[38:39], v25 offset:26624
    v_add_f32 v5, v5, v10
    v_cvt_pk_bf16_f32 v21, v10, v11
    v_add_f32 v5, v5, v11
    v_add_f32 v5, v5, v12
    v_cvt_pk_bf16_f32 v22, v12, v13
    v_add_f32 v5, v5, v13
    v_add_f32 v5, v5, v14
    v_cvt_pk_bf16_f32 v23, v14, v15
    v_add_f32 v5, v5, v15
    s_waitcnt lgkmcnt(12)
    v_mfma_f32_32x32x16_bf16 v[112:127], v[44:47], v[16:19], v[112:127]
    ds_read_b64_tr_b16 v[40:41], v26 offset:24576
    ds_read_b64_tr_b16 v[42:43], v26 offset:26624
    v_lshlrev_b32 v8, 16, v232
    v_and_b32 v9, 0xffff0000, v232
    v_lshlrev_b32 v10, 16, v233
    v_and_b32 v11, 0xffff0000, v233
    v_lshlrev_b32 v12, 16, v234
    v_and_b32 v13, 0xffff0000, v234
    v_lshlrev_b32 v14, 16, v235
    v_and_b32 v15, 0xffff0000, v235
    v_fma_f32 v8, v8, s63, v4
    s_waitcnt lgkmcnt(12)
    v_mfma_f32_32x32x16_bf16 v[64:79], v[48:51], v[20:23], v[64:79]
    ds_read_b64_tr_b16 v[44:45], v27 offset:24576
    ds_read_b64_tr_b16 v[46:47], v27 offset:26624
    v_fma_f32 v9, v9, s63, v4
    v_fma_f32 v10, v10, s63, v4
    v_fma_f32 v11, v11, s63, v4
    v_fma_f32 v12, v12, s63, v4
    v_fma_f32 v13, v13, s63, v4
    v_fma_f32 v14, v14, s63, v4
    v_fma_f32 v15, v15, s63, v4
    v_exp_f32 v8, v8
    v_exp_f32 v9, v9
    s_waitcnt lgkmcnt(12)
    v_mfma_f32_32x32x16_bf16 v[80:95], v[52:55], v[20:23], v[80:95]
    ds_read_b64_tr_b16 v[48:49], v24 offset:28672
    ds_read_b64_tr_b16 v[50:51], v24 offset:30720
    v_exp_f32 v10, v10
    v_exp_f32 v11, v11
    v_exp_f32 v12, v12
    v_exp_f32 v13, v13
    v_exp_f32 v14, v14
    v_exp_f32 v15, v15
    v_add_f32 v5, v5, v8
    v_cvt_pk_bf16_f32 v16, v8, v9
    v_add_f32 v5, v5, v9
    s_waitcnt lgkmcnt(12)
    v_mfma_f32_32x32x16_bf16 v[96:111], v[56:59], v[20:23], v[96:111]
    ds_read_b64_tr_b16 v[52:53], v25 offset:28672
    ds_read_b64_tr_b16 v[54:55], v25 offset:30720
    v_add_f32 v5, v5, v10
    v_cvt_pk_bf16_f32 v17, v10, v11
    v_add_f32 v5, v5, v11
    v_add_f32 v5, v5, v12
    v_cvt_pk_bf16_f32 v18, v12, v13
    v_add_f32 v5, v5, v13
    v_add_f32 v5, v5, v14
    v_cvt_pk_bf16_f32 v19, v14, v15
    v_add_f32 v5, v5, v15
    s_waitcnt lgkmcnt(12)
    v_mfma_f32_32x32x16_bf16 v[112:127], v[60:63], v[20:23], v[112:127]
    ds_read_b64_tr_b16 v[56:57], v26 offset:28672
    ds_read_b64_tr_b16 v[58:59], v26 offset:30720
    v_lshlrev_b32 v8, 16, v236
    v_and_b32 v9, 0xffff0000, v236
    v_lshlrev_b32 v10, 16, v237
    v_and_b32 v11, 0xffff0000, v237
    v_lshlrev_b32 v12, 16, v238
    v_and_b32 v13, 0xffff0000, v238
    v_lshlrev_b32 v14, 16, v239
    v_and_b32 v15, 0xffff0000, v239
    v_fma_f32 v8, v8, s63, v4
    s_waitcnt lgkmcnt(12)
    v_mfma_f32_32x32x16_bf16 v[64:79], v[32:35], v[16:19], v[64:79]
    ds_read_b64_tr_b16 v[60:61], v27 offset:28672
    ds_read_b64_tr_b16 v[62:63], v27 offset:30720
    v_fma_f32 v9, v9, s63, v4
    v_fma_f32 v10, v10, s63, v4
    v_fma_f32 v11, v11, s63, v4
    v_fma_f32 v12, v12, s63, v4
    v_fma_f32 v13, v13, s63, v4
    v_fma_f32 v14, v14, s63, v4
    v_fma_f32 v15, v15, s63, v4
    v_exp_f32 v8, v8
    v_exp_f32 v9, v9
    s_waitcnt lgkmcnt(12)
    v_mfma_f32_32x32x16_bf16 v[80:95], v[36:39], v[16:19], v[80:95]
    s_waitcnt vmcnt(0)
    s_barrier
    ds_read_b64_tr_b16 v[32:33], v28 offset:16384
    ds_read_b64_tr_b16 v[34:35], v28 offset:18432
    v_exp_f32 v10, v10
    v_exp_f32 v11, v11
    v_exp_f32 v12, v12
    v_exp_f32 v13, v13
    v_exp_f32 v14, v14
    v_exp_f32 v15, v15
    v_add_f32 v5, v5, v8
    v_cvt_pk_bf16_f32 v20, v8, v9
    v_add_f32 v5, v5, v9
    s_waitcnt lgkmcnt(12)
    v_mfma_f32_32x32x16_bf16 v[96:111], v[40:43], v[16:19], v[96:111]
    ds_read_b64_tr_b16 v[36:37], v29 offset:16384
    ds_read_b64_tr_b16 v[38:39], v29 offset:18432
    v_add_f32 v5, v5, v10
    v_cvt_pk_bf16_f32 v21, v10, v11
    v_add_f32 v5, v5, v11
    v_add_f32 v5, v5, v12
    v_cvt_pk_bf16_f32 v22, v12, v13
    v_add_f32 v5, v5, v13
    v_add_f32 v5, v5, v14
    v_cvt_pk_bf16_f32 v23, v14, v15
    v_add_f32 v5, v5, v15
    s_waitcnt lgkmcnt(12)
    v_mfma_f32_32x32x16_bf16 v[112:127], v[44:47], v[16:19], v[112:127]
    ds_read_b64_tr_b16 v[40:41], v30 offset:16384
    ds_read_b64_tr_b16 v[42:43], v30 offset:18432
    v_lshlrev_b32 v8, 16, v240
    v_and_b32 v9, 0xffff0000, v240
    v_lshlrev_b32 v10, 16, v241
    v_and_b32 v11, 0xffff0000, v241
    v_lshlrev_b32 v12, 16, v242
    v_and_b32 v13, 0xffff0000, v242
    v_lshlrev_b32 v14, 16, v243
    v_and_b32 v15, 0xffff0000, v243
    v_fma_f32 v8, v8, s63, v4
    s_waitcnt lgkmcnt(12)
    v_mfma_f32_32x32x16_bf16 v[64:79], v[48:51], v[20:23], v[64:79]
    ds_read_b64_tr_b16 v[44:45], v31 offset:16384
    ds_read_b64_tr_b16 v[46:47], v31 offset:18432
    v_fma_f32 v9, v9, s63, v4
    v_fma_f32 v10, v10, s63, v4
    v_fma_f32 v11, v11, s63, v4
    v_fma_f32 v12, v12, s63, v4
    v_fma_f32 v13, v13, s63, v4
    v_fma_f32 v14, v14, s63, v4
    v_fma_f32 v15, v15, s63, v4
    v_exp_f32 v8, v8
    v_exp_f32 v9, v9
    s_waitcnt lgkmcnt(12)
    v_mfma_f32_32x32x16_bf16 v[80:95], v[52:55], v[20:23], v[80:95]
    ds_read_b64_tr_b16 v[48:49], v28 offset:20480
    ds_read_b64_tr_b16 v[50:51], v28 offset:22528
    v_exp_f32 v10, v10
    v_exp_f32 v11, v11
    v_exp_f32 v12, v12
    v_exp_f32 v13, v13
    v_exp_f32 v14, v14
    v_exp_f32 v15, v15
    v_add_f32 v5, v5, v8
    v_cvt_pk_bf16_f32 v16, v8, v9
    v_add_f32 v5, v5, v9
    s_waitcnt lgkmcnt(12)
    v_mfma_f32_32x32x16_bf16 v[96:111], v[56:59], v[20:23], v[96:111]
    ds_read_b64_tr_b16 v[52:53], v29 offset:20480
    ds_read_b64_tr_b16 v[54:55], v29 offset:22528
    v_add_f32 v5, v5, v10
    v_cvt_pk_bf16_f32 v17, v10, v11
    v_add_f32 v5, v5, v11
    v_add_f32 v5, v5, v12
    v_cvt_pk_bf16_f32 v18, v12, v13
    v_add_f32 v5, v5, v13
    v_add_f32 v5, v5, v14
    v_cvt_pk_bf16_f32 v19, v14, v15
    v_add_f32 v5, v5, v15
    s_waitcnt lgkmcnt(12)
    v_mfma_f32_32x32x16_bf16 v[112:127], v[60:63], v[20:23], v[112:127]
    ds_read_b64_tr_b16 v[56:57], v30 offset:20480
    ds_read_b64_tr_b16 v[58:59], v30 offset:22528
    v_lshlrev_b32 v8, 16, v244
    v_and_b32 v9, 0xffff0000, v244
    v_lshlrev_b32 v10, 16, v245
    v_and_b32 v11, 0xffff0000, v245
    v_lshlrev_b32 v12, 16, v246
    v_and_b32 v13, 0xffff0000, v246
    v_lshlrev_b32 v14, 16, v247
    v_and_b32 v15, 0xffff0000, v247
    v_fma_f32 v8, v8, s63, v4
    s_waitcnt lgkmcnt(12)
    v_mfma_f32_32x32x16_bf16 v[64:79], v[32:35], v[16:19], v[64:79]
    ds_read_b64_tr_b16 v[60:61], v31 offset:20480
    ds_read_b64_tr_b16 v[62:63], v31 offset:22528
    v_fma_f32 v9, v9, s63, v4
    v_fma_f32 v10, v10, s63, v4
    v_fma_f32 v11, v11, s63, v4
    v_fma_f32 v12, v12, s63, v4
    v_fma_f32 v13, v13, s63, v4
    v_fma_f32 v14, v14, s63, v4
    v_fma_f32 v15, v15, s63, v4
    v_exp_f32 v8, v8
    v_exp_f32 v9, v9
    s_waitcnt lgkmcnt(12)
    v_mfma_f32_32x32x16_bf16 v[80:95], v[36:39], v[16:19], v[80:95]
    ds_read_b64_tr_b16 v[32:33], v28 offset:24576
    ds_read_b64_tr_b16 v[34:35], v28 offset:26624
    v_exp_f32 v10, v10
    v_exp_f32 v11, v11
    v_exp_f32 v12, v12
    v_exp_f32 v13, v13
    v_exp_f32 v14, v14
    v_exp_f32 v15, v15
    v_add_f32 v5, v5, v8
    v_cvt_pk_bf16_f32 v20, v8, v9
    v_add_f32 v5, v5, v9
    s_waitcnt lgkmcnt(12)
    v_mfma_f32_32x32x16_bf16 v[96:111], v[40:43], v[16:19], v[96:111]
    ds_read_b64_tr_b16 v[36:37], v29 offset:24576
    ds_read_b64_tr_b16 v[38:39], v29 offset:26624
    v_add_f32 v5, v5, v10
    v_cvt_pk_bf16_f32 v21, v10, v11
    v_add_f32 v5, v5, v11
    v_add_f32 v5, v5, v12
    v_cvt_pk_bf16_f32 v22, v12, v13
    v_add_f32 v5, v5, v13
    v_add_f32 v5, v5, v14
    v_cvt_pk_bf16_f32 v23, v14, v15
    v_add_f32 v5, v5, v15
    s_waitcnt lgkmcnt(12)
    v_mfma_f32_32x32x16_bf16 v[112:127], v[44:47], v[16:19], v[112:127]
    ds_read_b64_tr_b16 v[40:41], v30 offset:24576
    ds_read_b64_tr_b16 v[42:43], v30 offset:26624
    v_lshlrev_b32 v8, 16, v248
    v_and_b32 v9, 0xffff0000, v248
    v_lshlrev_b32 v10, 16, v249
    v_and_b32 v11, 0xffff0000, v249
    v_lshlrev_b32 v12, 16, v250
    v_and_b32 v13, 0xffff0000, v250
    v_lshlrev_b32 v14, 16, v251
    v_and_b32 v15, 0xffff0000, v251
    v_fma_f32 v8, v8, s63, v4
    s_waitcnt lgkmcnt(12)
    v_mfma_f32_32x32x16_bf16 v[64:79], v[48:51], v[20:23], v[64:79]
    ds_read_b64_tr_b16 v[44:45], v31 offset:24576
    ds_read_b64_tr_b16 v[46:47], v31 offset:26624
    v_fma_f32 v9, v9, s63, v4
    v_fma_f32 v10, v10, s63, v4
    v_fma_f32 v11, v11, s63, v4
    v_fma_f32 v12, v12, s63, v4
    v_fma_f32 v13, v13, s63, v4
    v_fma_f32 v14, v14, s63, v4
    v_fma_f32 v15, v15, s63, v4
    v_exp_f32 v8, v8
    v_exp_f32 v9, v9
    s_waitcnt lgkmcnt(12)
    v_mfma_f32_32x32x16_bf16 v[80:95], v[52:55], v[20:23], v[80:95]
    ds_read_b64_tr_b16 v[48:49], v28 offset:28672
    ds_read_b64_tr_b16 v[50:51], v28 offset:30720
    v_exp_f32 v10, v10
    v_exp_f32 v11, v11
    v_exp_f32 v12, v12
    v_exp_f32 v13, v13
    v_exp_f32 v14, v14
    v_exp_f32 v15, v15
    v_add_f32 v5, v5, v8
    v_cvt_pk_bf16_f32 v16, v8, v9
    v_add_f32 v5, v5, v9
    s_waitcnt lgkmcnt(12)
    v_mfma_f32_32x32x16_bf16 v[96:111], v[56:59], v[20:23], v[96:111]
    ds_read_b64_tr_b16 v[52:53], v29 offset:28672
    ds_read_b64_tr_b16 v[54:55], v29 offset:30720
    v_add_f32 v5, v5, v10
    v_cvt_pk_bf16_f32 v17, v10, v11
    v_add_f32 v5, v5, v11
    v_add_f32 v5, v5, v12
    v_cvt_pk_bf16_f32 v18, v12, v13
    v_add_f32 v5, v5, v13
    v_add_f32 v5, v5, v14
    v_cvt_pk_bf16_f32 v19, v14, v15
    v_add_f32 v5, v5, v15
    s_waitcnt lgkmcnt(12)
    v_mfma_f32_32x32x16_bf16 v[112:127], v[60:63], v[20:23], v[112:127]
    ds_read_b64_tr_b16 v[56:57], v30 offset:28672
    ds_read_b64_tr_b16 v[58:59], v30 offset:30720
    v_lshlrev_b32 v8, 16, v252
    v_and_b32 v9, 0xffff0000, v252
    v_lshlrev_b32 v10, 16, v253
    v_and_b32 v11, 0xffff0000, v253
    v_lshlrev_b32 v12, 16, v254
    v_and_b32 v13, 0xffff0000, v254
    v_lshlrev_b32 v14, 16, v255
    v_and_b32 v15, 0xffff0000, v255
    v_fma_f32 v8, v8, s63, v4
    s_waitcnt lgkmcnt(12)
    v_mfma_f32_32x32x16_bf16 v[64:79], v[32:35], v[16:19], v[64:79]
    ds_read_b64_tr_b16 v[60:61], v31 offset:28672
    ds_read_b64_tr_b16 v[62:63], v31 offset:30720
    v_fma_f32 v9, v9, s63, v4
    v_fma_f32 v10, v10, s63, v4
    v_fma_f32 v11, v11, s63, v4
    v_fma_f32 v12, v12, s63, v4
    v_fma_f32 v13, v13, s63, v4
    v_fma_f32 v14, v14, s63, v4
    v_fma_f32 v15, v15, s63, v4
    v_exp_f32 v8, v8
    v_exp_f32 v9, v9
    s_waitcnt lgkmcnt(12)
    v_mfma_f32_32x32x16_bf16 v[80:95], v[36:39], v[16:19], v[80:95]
    v_exp_f32 v10, v10
    v_exp_f32 v11, v11
    v_exp_f32 v12, v12
    v_exp_f32 v13, v13
    v_exp_f32 v14, v14
    v_exp_f32 v15, v15
    v_add_f32 v5, v5, v8
    v_cvt_pk_bf16_f32 v20, v8, v9
    v_add_f32 v5, v5, v9
    s_waitcnt lgkmcnt(10)
    v_mfma_f32_32x32x16_bf16 v[96:111], v[40:43], v[16:19], v[96:111]
    v_add_f32 v5, v5, v10
    v_cvt_pk_bf16_f32 v21, v10, v11
    v_add_f32 v5, v5, v11
    v_add_f32 v5, v5, v12
    v_cvt_pk_bf16_f32 v22, v12, v13
    v_add_f32 v5, v5, v13
    v_add_f32 v5, v5, v14
    v_cvt_pk_bf16_f32 v23, v14, v15
    v_add_f32 v5, v5, v15
    s_waitcnt lgkmcnt(8)
    v_mfma_f32_32x32x16_bf16 v[112:127], v[44:47], v[16:19], v[112:127]
    s_waitcnt lgkmcnt(6)
    v_mfma_f32_32x32x16_bf16 v[64:79], v[48:51], v[20:23], v[64:79]
    s_waitcnt lgkmcnt(4)
    v_mfma_f32_32x32x16_bf16 v[80:95], v[52:55], v[20:23], v[80:95]
    s_waitcnt lgkmcnt(2)
    v_mfma_f32_32x32x16_bf16 v[96:111], v[56:59], v[20:23], v[96:111]
    s_waitcnt lgkmcnt(0)
    v_mfma_f32_32x32x16_bf16 v[112:127], v[60:63], v[20:23], v[112:127]
    s_and_b32 s80, s2, 511
    s_lshl_b32 s81, s80, 2
    s_add_u32 s81, s81, s60
    s_and_b32 s82, s81, 255
    s_lshr_b32 s83, s80, 6
    s_lshl_b32 s82, s82, 14
    s_lshl_b32 s83, s83, 7
    s_add_u32 s82, s82, s83
    s_add_u32 s83, s82, 4096
    v_lshrrev_b32 v9, 5, v0
    v_lshlrev_b32 v9, 13, v9
    v_and_b32 v10, 31, v0
    v_lshlrev_b32 v10, 1, v10
    v_add_u32 v9, v9, v10
    buffer_load_ushort v32, v9, s[76:79], s82 offen offset:0
    buffer_load_ushort v33, v9, s[76:79], s82 offen offset:1024
    buffer_load_ushort v34, v9, s[76:79], s82 offen offset:2048
    buffer_load_ushort v35, v9, s[76:79], s82 offen offset:3072
    buffer_load_ushort v36, v9, s[76:79], s83 offen offset:0
    buffer_load_ushort v37, v9, s[76:79], s83 offen offset:1024
    buffer_load_ushort v38, v9, s[76:79], s83 offen offset:2048
    buffer_load_ushort v39, v9, s[76:79], s83 offen offset:3072
    buffer_load_ushort v40, v9, s[76:79], s82 offen offset:64
    buffer_load_ushort v41, v9, s[76:79], s82 offen offset:1088
    buffer_load_ushort v42, v9, s[76:79], s82 offen offset:2112
    buffer_load_ushort v43, v9, s[76:79], s82 offen offset:3136
    buffer_load_ushort v44, v9, s[76:79], s83 offen offset:64
    buffer_load_ushort v45, v9, s[76:79], s83 offen offset:1088
    buffer_load_ushort v46, v9, s[76:79], s83 offen offset:2112
    buffer_load_ushort v47, v9, s[76:79], s83 offen offset:3136
    v_mov_b32 v8, v5
    s_nop 1
    v_permlane32_swap_b32 v5, v8
    v_add_f32 v5, v5, v8
    v_rcp_f32 v5, v5
    s_lshl_b32 s68, s5, 24
    s_lshl_b32 s69, s7, 20
    s_add_u32 s68, s68, s69
    s_lshl_b32 s69, s60, 18
    s_add_u32 s68, s68, s69
    s_lshl_b32 s69, s8, 13
    s_add_u32 s68, s68, s69
    v_lshlrev_b32 v8, 4, v0
    v_mul_f32 v64, v64, v5
    v_mul_f32 v65, v65, v5
    v_mul_f32 v66, v66, v5
    v_mul_f32 v67, v67, v5
    v_mul_f32 v68, v68, v5
    v_mul_f32 v69, v69, v5
    v_mul_f32 v70, v70, v5
    v_mul_f32 v71, v71, v5
    v_cvt_pk_bf16_f32 v64, v64, v65
    v_cvt_pk_bf16_f32 v65, v66, v67
    v_cvt_pk_bf16_f32 v66, v68, v69
    v_cvt_pk_bf16_f32 v67, v70, v71
    v_mul_f32 v72, v72, v5
    v_mul_f32 v73, v73, v5
    v_mul_f32 v74, v74, v5
    v_mul_f32 v75, v75, v5
    v_mul_f32 v76, v76, v5
    v_mul_f32 v77, v77, v5
    v_mul_f32 v78, v78, v5
    v_mul_f32 v79, v79, v5
    v_cvt_pk_bf16_f32 v68, v72, v73
    v_cvt_pk_bf16_f32 v69, v74, v75
    v_cvt_pk_bf16_f32 v70, v76, v77
    v_cvt_pk_bf16_f32 v71, v78, v79
    v_mul_f32 v80, v80, v5
    v_mul_f32 v81, v81, v5
    v_mul_f32 v82, v82, v5
    v_mul_f32 v83, v83, v5
    v_mul_f32 v84, v84, v5
    v_mul_f32 v85, v85, v5
    v_mul_f32 v86, v86, v5
    v_mul_f32 v87, v87, v5
    v_cvt_pk_bf16_f32 v72, v80, v81
    v_cvt_pk_bf16_f32 v73, v82, v83
    v_cvt_pk_bf16_f32 v74, v84, v85
    v_cvt_pk_bf16_f32 v75, v86, v87
    v_mul_f32 v88, v88, v5
    v_mul_f32 v89, v89, v5
    v_mul_f32 v90, v90, v5
    v_mul_f32 v91, v91, v5
    v_mul_f32 v92, v92, v5
    v_mul_f32 v93, v93, v5
    v_mul_f32 v94, v94, v5
    v_mul_f32 v95, v95, v5
    v_cvt_pk_bf16_f32 v76, v88, v89
    v_cvt_pk_bf16_f32 v77, v90, v91
    v_cvt_pk_bf16_f32 v78, v92, v93
    v_cvt_pk_bf16_f32 v79, v94, v95
    v_mul_f32 v96, v96, v5
    v_mul_f32 v97, v97, v5
    v_mul_f32 v98, v98, v5
    v_mul_f32 v99, v99, v5
    v_mul_f32 v100, v100, v5
    v_mul_f32 v101, v101, v5
    v_mul_f32 v102, v102, v5
    v_mul_f32 v103, v103, v5
    v_cvt_pk_bf16_f32 v80, v96, v97
    v_cvt_pk_bf16_f32 v81, v98, v99
    v_cvt_pk_bf16_f32 v82, v100, v101
    v_cvt_pk_bf16_f32 v83, v102, v103
    v_mul_f32 v104, v104, v5
    v_mul_f32 v105, v105, v5
    v_mul_f32 v106, v106, v5
    v_mul_f32 v107, v107, v5
    v_mul_f32 v108, v108, v5
    v_mul_f32 v109, v109, v5
    v_mul_f32 v110, v110, v5
    v_mul_f32 v111, v111, v5
    v_cvt_pk_bf16_f32 v84, v104, v105
    v_cvt_pk_bf16_f32 v85, v106, v107
    v_cvt_pk_bf16_f32 v86, v108, v109
    v_cvt_pk_bf16_f32 v87, v110, v111
    v_mul_f32 v112, v112, v5
    v_mul_f32 v113, v113, v5
    v_mul_f32 v114, v114, v5
    v_mul_f32 v115, v115, v5
    v_mul_f32 v116, v116, v5
    v_mul_f32 v117, v117, v5
    v_mul_f32 v118, v118, v5
    v_mul_f32 v119, v119, v5
    v_cvt_pk_bf16_f32 v88, v112, v113
    v_cvt_pk_bf16_f32 v89, v114, v115
    v_cvt_pk_bf16_f32 v90, v116, v117
    v_cvt_pk_bf16_f32 v91, v118, v119
    v_mul_f32 v120, v120, v5
    v_mul_f32 v121, v121, v5
    v_mul_f32 v122, v122, v5
    v_mul_f32 v123, v123, v5
    v_mul_f32 v124, v124, v5
    v_mul_f32 v125, v125, v5
    v_mul_f32 v126, v126, v5
    v_mul_f32 v127, v127, v5
    v_cvt_pk_bf16_f32 v92, v120, v121
    v_cvt_pk_bf16_f32 v93, v122, v123
    v_cvt_pk_bf16_f32 v94, v124, v125
    v_cvt_pk_bf16_f32 v95, v126, v127
    v_permlane32_swap_b32 v64, v66
    v_permlane32_swap_b32 v65, v67
    v_permlane32_swap_b32 v68, v70
    v_permlane32_swap_b32 v69, v71
    v_permlane32_swap_b32 v72, v74
    v_permlane32_swap_b32 v73, v75
    v_permlane32_swap_b32 v76, v78
    v_permlane32_swap_b32 v77, v79
    v_permlane32_swap_b32 v80, v82
    v_permlane32_swap_b32 v81, v83
    v_permlane32_swap_b32 v84, v86
    v_permlane32_swap_b32 v85, v87
    v_permlane32_swap_b32 v88, v90
    v_permlane32_swap_b32 v89, v91
    v_permlane32_swap_b32 v92, v94
    v_permlane32_swap_b32 v93, v95
    buffer_store_dwordx4 v[64:67], v8, s[56:59], s68 offen offset:0 sc1
    buffer_store_dwordx4 v[68:71], v8, s[56:59], s68 offen offset:1024 sc1
    buffer_store_dwordx4 v[72:75], v8, s[56:59], s68 offen offset:2048 sc1
    buffer_store_dwordx4 v[76:79], v8, s[56:59], s68 offen offset:3072 sc1
    s_add_u32 s68, s68, 4096
    buffer_store_dwordx4 v[80:83], v8, s[56:59], s68 offen offset:0 sc1
    buffer_store_dwordx4 v[84:87], v8, s[56:59], s68 offen offset:1024 sc1
    buffer_store_dwordx4 v[88:91], v8, s[56:59], s68 offen offset:2048 sc1
    buffer_store_dwordx4 v[92:95], v8, s[56:59], s68 offen offset:3072 sc1
    s_lshl_b32 s84, s72, 22
    s_lshl_b32 s85, s81, 11
    s_add_u32 s84, s84, s85
    s_add_u32 s84, s84, 33554432
    s_waitcnt vmcnt(22)
    v_lshl_or_b32 v16, v33, 16, v32
    s_waitcnt vmcnt(20)
    v_lshl_or_b32 v17, v35, 16, v34
    s_waitcnt vmcnt(18)
    v_lshl_or_b32 v18, v37, 16, v36
    s_waitcnt vmcnt(16)
    v_lshl_or_b32 v19, v39, 16, v38
    s_waitcnt vmcnt(14)
    v_lshl_or_b32 v20, v41, 16, v40
    s_waitcnt vmcnt(12)
    v_lshl_or_b32 v21, v43, 16, v42
    s_waitcnt vmcnt(10)
    v_lshl_or_b32 v22, v45, 16, v44
    s_waitcnt vmcnt(8)
    v_lshl_or_b32 v23, v47, 16, v46
    buffer_store_dwordx4 v[16:19], v8, s[56:59], s84 offen offset:0 sc1
    buffer_store_dwordx4 v[20:23], v8, s[56:59], s84 offen offset:1024 sc1
L_attn_end:
    s_endpgm
.p2align 8
oproj_kernel:
    s_cmp_ge_u32 s2, 256
    s_cbranch_scc1 L_oproj_end
    s_load_dwordx2 s[20:21], s[0:1], 80
    s_load_dwordx2 s[22:23], s[0:1], 96
    s_and_b32 s3, s2, 7
    s_lshr_b32 s4, s2, 3
    s_lshr_b32 s5, s3, 2
    s_and_b32 s6, s3, 3
    s_lshl_b32 s6, s6, 2
    s_lshr_b32 s7, s4, 3
    s_add_u32 s6, s6, s7
    s_and_b32 s7, s4, 7
    v_lshrrev_b32 v1, 6, v0
    v_and_b32 v0, 63, v0
    v_readfirstlane_b32 s60, v1
    s_waitcnt lgkmcnt(0)
    s_mov_b32 s44, s22
    s_and_b32 s45, s23, 0xffff
    s_mov_b32 s46, 54525952
    s_mov_b32 s47, 0x00020000
    s_mov_b32 s48, s20
    s_and_b32 s49, s21, 0xffff
    s_mov_b32 s50, 4194304
    s_mov_b32 s51, 0x00020000
    s_lshl_b32 s65, s60, 12
    s_lshl_b32 s64, s7, 7
    s_lshl_b32 s71, s5, 22
    s_lshl_b32 s69, s7, 19
    s_add_u32 s71, s71, s69
    s_add_u32 s71, s71, 33554432
    v_lshlrev_b32 v2, 4, v0
    v_add_u32 v1, s65, v2
    v_add_u32 v3, 0xc000, v2
    v_add_u32 v4, 0x18000, v2
    s_lshl_b32 s68, s5, 24
    s_lshl_b32 s69, s6, 20
    s_add_u32 s68, s68, s69
    s_lshl_b32 s69, s60, 18
    s_add_u32 s68, s68, s69
    s_add_u32 m0, s65, 0
    s_add_u32 s62, s71, 0
    buffer_load_dwordx4 v1, s[44:47], s62 offen offset:0 lds
    buffer_load_dwordx4 v1, s[44:47], s62 offen offset:1024 lds
    buffer_load_dwordx4 v1, s[44:47], s62 offen offset:2048 lds
    buffer_load_dwordx4 v1, s[44:47], s62 offen offset:3072 lds
    buffer_load_dwordx4 v[96:99], v2, s[44:47], s68 offen offset:0
    buffer_load_dwordx4 v[100:103], v2, s[44:47], s68 offen offset:1024
    buffer_load_dwordx4 v[104:107], v2, s[44:47], s68 offen offset:2048
    buffer_load_dwordx4 v[108:111], v2, s[44:47], s68 offen offset:3072
    s_add_u32 s68, s68, 4096
    buffer_load_dwordx4 v[112:115], v2, s[44:47], s68 offen offset:0
    buffer_load_dwordx4 v[116:119], v2, s[44:47], s68 offen offset:1024
    buffer_load_dwordx4 v[120:123], v2, s[44:47], s68 offen offset:2048
    buffer_load_dwordx4 v[124:127], v2, s[44:47], s68 offen offset:3072
    s_add_u32 m0, s65, 16384
    s_add_u32 s62, s71, 16384
    buffer_load_dwordx4 v1, s[44:47], s62 offen offset:0 lds
    buffer_load_dwordx4 v1, s[44:47], s62 offen offset:1024 lds
    buffer_load_dwordx4 v1, s[44:47], s62 offen offset:2048 lds
    buffer_load_dwordx4 v1, s[44:47], s62 offen offset:3072 lds
    s_add_u32 m0, s65, 32768
    s_add_u32 s62, s71, 32768
    buffer_load_dwordx4 v1, s[44:47], s62 offen offset:0 lds
    buffer_load_dwordx4 v1, s[44:47], s62 offen offset:1024 lds
    buffer_load_dwordx4 v1, s[44:47], s62 offen offset:2048 lds
    buffer_load_dwordx4 v1, s[44:47], s62 offen offset:3072 lds
    s_add_u32 m0, s65, 49152
    s_add_u32 s62, s71, 49152
    buffer_load_dwordx4 v1, s[44:47], s62 offen offset:0 lds
    buffer_load_dwordx4 v1, s[44:47], s62 offen offset:1024 lds
    buffer_load_dwordx4 v1, s[44:47], s62 offen offset:2048 lds
    buffer_load_dwordx4 v1, s[44:47], s62 offen offset:3072 lds
    s_add_u32 m0, s65, 65536
    s_add_u32 s62, s71, 65536
    buffer_load_dwordx4 v1, s[44:47], s62 offen offset:0 lds
    buffer_load_dwordx4 v1, s[44:47], s62 offen offset:1024 lds
    buffer_load_dwordx4 v1, s[44:47], s62 offen offset:2048 lds
    buffer_load_dwordx4 v1, s[44:47], s62 offen offset:3072 lds
    s_add_u32 m0, s65, 81920
    s_add_u32 s62, s71, 81920
    buffer_load_dwordx4 v1, s[44:47], s62 offen offset:0 lds
    buffer_load_dwordx4 v1, s[44:47], s62 offen offset:1024 lds
    buffer_load_dwordx4 v1, s[44:47], s62 offen offset:2048 lds
    buffer_load_dwordx4 v1, s[44:47], s62 offen offset:3072 lds
    s_add_u32 s68, s68, 4096
    buffer_load_dwordx4 v[128:131], v2, s[44:47], s68 offen offset:0
    buffer_load_dwordx4 v[132:135], v2, s[44:47], s68 offen offset:1024
    buffer_load_dwordx4 v[136:139], v2, s[44:47], s68 offen offset:2048
    buffer_load_dwordx4 v[140:143], v2, s[44:47], s68 offen offset:3072
    s_add_u32 s68, s68, 4096
    buffer_load_dwordx4 v[144:147], v2, s[44:47], s68 offen offset:0
    buffer_load_dwordx4 v[148:151], v2, s[44:47], s68 offen offset:1024
    buffer_load_dwordx4 v[152:155], v2, s[44:47], s68 offen offset:2048
    buffer_load_dwordx4 v[156:159], v2, s[44:47], s68 offen offset:3072
    s_add_u32 s68, s68, 4096
    buffer_load_dwordx4 v[160:163], v2, s[44:47], s68 offen offset:0
    buffer_load_dwordx4 v[164:167], v2, s[44:47], s68 offen offset:1024
    buffer_load_dwordx4 v[168:171], v2, s[44:47], s68 offen offset:2048
    buffer_load_dwordx4 v[172:175], v2, s[44:47], s68 offen offset:3072
    s_waitcnt vmcnt(40)
    s_barrier
    ds_read_b128 v[32:35], v2 offset:0
    ds_read_b128 v[36:39], v2 offset:1024
    ds_read_b128 v[40:43], v2 offset:2048
    ds_read_b128 v[44:47], v2 offset:3072
    ds_read_b128 v[48:51], v2 offset:4096
    ds_read_b128 v[52:55], v2 offset:5120
    ds_read_b128 v[56:59], v2 offset:6144
    s_waitcnt vmcnt(39) lgkmcnt(6)
    v_mfma_f32_32x32x16_bf16 v[64:79], v[32:35], v[96:99], 0
    ds_read_b128 v[60:63], v2 offset:7168
    s_add_u32 s68, s68, 4096
    buffer_load_dwordx4 v[176:179], v2, s[44:47], s68 offen offset:0
    s_waitcnt lgkmcnt(6)
    v_mfma_f32_32x32x16_bf16 v[80:95], v[36:39], v[96:99], 0
    ds_read_b128 v[32:35], v2 offset:8192
    s_waitcnt vmcnt(39) lgkmcnt(6)
    v_mfma_f32_32x32x16_bf16 v[64:79], v[40:43], v[100:103], v[64:79]
    ds_read_b128 v[36:39], v2 offset:9216
    buffer_load_dwordx4 v[180:183], v2, s[44:47], s68 offen offset:1024
    s_waitcnt lgkmcnt(6)
    v_mfma_f32_32x32x16_bf16 v[80:95], v[44:47], v[100:103], v[80:95]
    ds_read_b128 v[40:43], v2 offset:10240
    s_waitcnt vmcnt(39) lgkmcnt(6)
    v_mfma_f32_32x32x16_bf16 v[64:79], v[48:51], v[104:107], v[64:79]
    ds_read_b128 v[44:47], v2 offset:11264
    buffer_load_dwordx4 v[184:187], v2, s[44:47], s68 offen offset:2048
    s_waitcnt lgkmcnt(6)
    v_mfma_f32_32x32x16_bf16 v[80:95], v[52:55], v[104:107], v[80:95]
    ds_read_b128 v[48:51], v2 offset:12288
    s_waitcnt vmcnt(39) lgkmcnt(6)
    v_mfma_f32_32x32x16_bf16 v[64:79], v[56:59], v[108:111], v[64:79]
    ds_read_b128 v[52:55], v2 offset:13312
    buffer_load_dwordx4 v[188:191], v2, s[44:47], s68 offen offset:3072
    s_waitcnt lgkmcnt(6)
    v_mfma_f32_32x32x16_bf16 v[80:95], v[60:63], v[108:111], v[80:95]
    ds_read_b128 v[56:59], v2 offset:14336
    s_waitcnt vmcnt(39) lgkmcnt(6)
    v_mfma_f32_32x32x16_bf16 v[64:79], v[32:35], v[112:115], v[64:79]
    ds_read_b128 v[60:63], v2 offset:15360
    s_add_u32 s68, s68, 4096
    buffer_load_dwordx4 v[96:99], v2, s[44:47], s68 offen offset:0
    s_waitcnt lgkmcnt(6)
    v_mfma_f32_32x32x16_bf16 v[80:95], v[36:39], v[112:115], v[80:95]
    s_waitcnt vmcnt(33)
    s_barrier
    ds_read_b128 v[32:35], v2 offset:16384
    s_waitcnt lgkmcnt(6)
    v_mfma_f32_32x32x16_bf16 v[64:79], v[40:43], v[116:119], v[64:79]
    ds_read_b128 v[36:39], v2 offset:17408
    buffer_load_dwordx4 v[100:103], v2, s[44:47], s68 offen offset:1024
    s_waitcnt lgkmcnt(6)
    v_mfma_f32_32x32x16_bf16 v[80:95], v[44:47], v[116:119], v[80:95]
    ds_read_b128 v[40:43], v2 offset:18432
    s_waitcnt lgkmcnt(6)
    v_mfma_f32_32x32x16_bf16 v[64:79], v[48:51], v[120:123], v[64:79]
    ds_read_b128 v[44:47], v2 offset:19456
    buffer_load_dwordx4 v[104:107], v2, s[44:47], s68 offen offset:2048
    s_waitcnt lgkmcnt(6)
    v_mfma_f32_32x32x16_bf16 v[80:95], v[52:55], v[120:123], v[80:95]
    ds_read_b128 v[48:51], v2 offset:20480
    s_waitcnt lgkmcnt(6)
    v_mfma_f32_32x32x16_bf16 v[64:79], v[56:59], v[124:127], v[64:79]
    ds_read_b128 v[52:55], v2 offset:21504
    buffer_load_dwordx4 v[108:111], v2, s[44:47], s68 offen offset:3072
    s_waitcnt lgkmcnt(6)
    v_mfma_f32_32x32x16_bf16 v[80:95], v[60:63], v[124:127], v[80:95]
    ds_read_b128 v[56:59], v2 offset:22528
    s_waitcnt vmcnt(19) lgkmcnt(6)
    v_mfma_f32_32x32x16_bf16 v[64:79], v[32:35], v[128:131], v[64:79]
    ds_read_b128 v[60:63], v2 offset:23552
    s_add_u32 s68, s68, 4096
    buffer_load_dwordx4 v[112:115], v2, s[44:47], s68 offen offset:0
    s_waitcnt lgkmcnt(6)
    v_mfma_f32_32x32x16_bf16 v[80:95], v[36:39], v[128:131], v[80:95]
    ds_read_b128 v[32:35], v2 offset:24576
    s_waitcnt vmcnt(19) lgkmcnt(6)
    v_mfma_f32_32x32x16_bf16 v[64:79], v[40:43], v[132:135], v[64:79]
    ds_read_b128 v[36:39], v2 offset:25600
    buffer_load_dwordx4 v[116:119], v2, s[44:47], s68 offen offset:1024
    s_waitcnt lgkmcnt(6)
    v_mfma_f32_32x32x16_bf16 v[80:95], v[44:47], v[132:135], v[80:95]
    ds_read_b128 v[40:43], v2 offset:26624
    s_waitcnt vmcnt(19) lgkmcnt(6)
    v_mfma_f32_32x32x16_bf16 v[64:79], v[48:51], v[136:139], v[64:79]
    ds_read_b128 v[44:47], v2 offset:27648
    buffer_load_dwordx4 v[120:123], v2, s[44:47], s68 offen offset:2048
    s_waitcnt lgkmcnt(6)
    v_mfma_f32_32x32x16_bf16 v[80:95], v[52:55], v[136:139], v[80:95]
    ds_read_b128 v[48:51], v2 offset:28672
    s_waitcnt vmcnt(19) lgkmcnt(6)
    v_mfma_f32_32x32x16_bf16 v[64:79], v[56:59], v[140:143], v[64:79]
    ds_read_b128 v[52:55], v2 offset:29696
    buffer_load_dwordx4 v[124:127], v2, s[44:47], s68 offen offset:3072
    s_waitcnt lgkmcnt(6)
    v_mfma_f32_32x32x16_bf16 v[80:95], v[60:63], v[140:143], v[80:95]
    ds_read_b128 v[56:59], v2 offset:30720
    s_waitcnt vmcnt(19) lgkmcnt(6)
    v_mfma_f32_32x32x16_bf16 v[64:79], v[32:35], v[144:147], v[64:79]
    ds_read_b128 v[60:63], v2 offset:31744
    s_add_u32 s68, s68, 4096
    buffer_load_dwordx4 v[128:131], v2, s[44:47], s68 offen offset:0
    s_waitcnt lgkmcnt(6)
    v_mfma_f32_32x32x16_bf16 v[80:95], v[36:39], v[144:147], v[80:95]
    s_barrier
    s_add_u32 m0, s65, 0
    s_add_u32 s62, s71, 98304
    buffer_load_dwordx4 v1, s[44:47], s62 offen offset:0 lds
    buffer_load_dwordx4 v1, s[44:47], s62 offen offset:1024 lds
    buffer_load_dwordx4 v1, s[44:47], s62 offen offset:2048 lds
    buffer_load_dwordx4 v1, s[44:47], s62 offen offset:3072 lds
    ds_read_b128 v[32:35], v2 offset:32768
    s_waitcnt vmcnt(23) lgkmcnt(6)
    v_mfma_f32_32x32x16_bf16 v[64:79], v[40:43], v[148:151], v[64:79]
    ds_read_b128 v[36:39], v2 offset:33792
    buffer_load_dwordx4 v[132:135], v2, s[44:47], s68 offen offset:1024
    s_waitcnt lgkmcnt(6)
    v_mfma_f32_32x32x16_bf16 v[80:95], v[44:47], v[148:151], v[80:95]
    ds_read_b128 v[40:43], v2 offset:34816
    s_waitcnt vmcnt(23) lgkmcnt(6)
    v_mfma_f32_32x32x16_bf16 v[64:79], v[48:51], v[152:155], v[64:79]
    ds_read_b128 v[44:47], v2 offset:35840
    buffer_load_dwordx4 v[136:139], v2, s[44:47], s68 offen offset:2048
    s_waitcnt lgkmcnt(6)
    v_mfma_f32_32x32x16_bf16 v[80:95], v[52:55], v[152:155], v[80:95]
    ds_read_b128 v[48:51], v2 offset:36864
    s_waitcnt vmcnt(23) lgkmcnt(6)
    v_mfma_f32_32x32x16_bf16 v[64:79], v[56:59], v[156:159], v[64:79]
    ds_read_b128 v[52:55], v2 offset:37888
    buffer_load_dwordx4 v[140:143], v2, s[44:47], s68 offen offset:3072
    s_waitcnt lgkmcnt(6)
    v_mfma_f32_32x32x16_bf16 v[80:95], v[60:63], v[156:159], v[80:95]
    ds_read_b128 v[56:59], v2 offset:38912
    s_waitcnt vmcnt(23) lgkmcnt(6)
    v_mfma_f32_32x32x16_bf16 v[64:79], v[32:35], v[160:163], v[64:79]
    ds_read_b128 v[60:63], v2 offset:39936
    s_add_u32 s68, s68, 4096
    buffer_load_dwordx4 v[144:147], v2, s[44:47], s68 offen offset:0
    s_waitcnt lgkmcnt(6)
    v_mfma_f32_32x32x16_bf16 v[80:95], v[36:39], v[160:163], v[80:95]
    ds_read_b128 v[32:35], v2 offset:40960
    s_waitcnt vmcnt(23) lgkmcnt(6)
    v_mfma_f32_32x32x16_bf16 v[64:79], v[40:43], v[164:167], v[64:79]
    ds_read_b128 v[36:39], v2 offset:41984
    buffer_load_dwordx4 v[148:151], v2, s[44:47], s68 offen offset:1024
    s_waitcnt lgkmcnt(6)
    v_mfma_f32_32x32x16_bf16 v[80:95], v[44:47], v[164:167], v[80:95]
    ds_read_b128 v[40:43], v2 offset:43008
    s_waitcnt vmcnt(23) lgkmcnt(6)
    v_mfma_f32_32x32x16_bf16 v[64:79], v[48:51], v[168:171], v[64:79]
    ds_read_b128 v[44:47], v2 offset:44032
    buffer_load_dwordx4 v[152:155], v2, s[44:47], s68 offen offset:2048
    s_waitcnt lgkmcnt(6)
    v_mfma_f32_32x32x16_bf16 v[80:95], v[52:55], v[168:171], v[80:95]
    ds_read_b128 v[48:51], v2 offset:45056
    s_waitcnt vmcnt(23) lgkmcnt(6)
    v_mfma_f32_32x32x16_bf16 v[64:79], v[56:59], v[172:175], v[64:79]
    ds_read_b128 v[52:55], v2 offset:46080
    buffer_load_dwordx4 v[156:159], v2, s[44:47], s68 offen offset:3072
    s_waitcnt lgkmcnt(6)
    v_mfma_f32_32x32x16_bf16 v[80:95], v[60:63], v[172:175], v[80:95]
    ds_read_b128 v[56:59], v2 offset:47104
    s_waitcnt vmcnt(23) lgkmcnt(6)
    v_mfma_f32_32x32x16_bf16 v[64:79], v[32:35], v[176:179], v[64:79]
    ds_read_b128 v[60:63], v2 offset:48128
    s_add_u32 s68, s68, 4096
    buffer_load_dwordx4 v[160:163], v2, s[44:47], s68 offen offset:0
    s_waitcnt lgkmcnt(6)
    v_mfma_f32_32x32x16_bf16 v[80:95], v[36:39], v[176:179], v[80:95]
    s_barrier
    s_add_u32 m0, s65, 16384
    s_add_u32 s62, s71, 114688
    buffer_load_dwordx4 v1, s[44:47], s62 offen offset:0 lds
    buffer_load_dwordx4 v1, s[44:47], s62 offen offset:1024 lds
    buffer_load_dwordx4 v1, s[44:47], s62 offen offset:2048 lds
    buffer_load_dwordx4 v1, s[44:47], s62 offen offset:3072 lds
    ds_read_b128 v[32:35], v3 offset:0
    s_waitcnt vmcnt(27) lgkmcnt(6)
    v_mfma_f32_32x32x16_bf16 v[64:79], v[40:43], v[180:183], v[64:79]
    ds_read_b128 v[36:39], v3 offset:1024
    buffer_load_dwordx4 v[164:167], v2, s[44:47], s68 offen offset:1024
    s_waitcnt lgkmcnt(6)
    v_mfma_f32_32x32x16_bf16 v[80:95], v[44:47], v[180:183], v[80:95]
    ds_read_b128 v[40:43], v3 offset:2048
    s_waitcnt vmcnt(27) lgkmcnt(6)
    v_mfma_f32_32x32x16_bf16 v[64:79], v[48:51], v[184:187], v[64:79]
    ds_read_b128 v[44:47], v3 offset:3072
    buffer_load_dwordx4 v[168:171], v2, s[44:47], s68 offen offset:2048
    s_waitcnt lgkmcnt(6)
    v_mfma_f32_32x32x16_bf16 v[80:95], v[52:55], v[184:187], v[80:95]
    ds_read_b128 v[48:51], v3 offset:4096
    s_waitcnt vmcnt(27) lgkmcnt(6)
    v_mfma_f32_32x32x16_bf16 v[64:79], v[56:59], v[188:191], v[64:79]
    ds_read_b128 v[52:55], v3 offset:5120
    buffer_load_dwordx4 v[172:175], v2, s[44:47], s68 offen offset:3072
    s_waitcnt lgkmcnt(6)
    v_mfma_f32_32x32x16_bf16 v[80:95], v[60:63], v[188:191], v[80:95]
    ds_read_b128 v[56:59], v3 offset:6144
    s_waitcnt vmcnt(27) lgkmcnt(6)
    v_mfma_f32_32x32x16_bf16 v[64:79], v[32:35], v[96:99], v[64:79]
    ds_read_b128 v[60:63], v3 offset:7168
    s_add_u32 s68, s68, 4096
    buffer_load_dwordx4 v[176:179], v2, s[44:47], s68 offen offset:0
    s_waitcnt lgkmcnt(6)
    v_mfma_f32_32x32x16_bf16 v[80:95], v[36:39], v[96:99], v[80:95]
    ds_read_b128 v[32:35], v3 offset:8192
    s_waitcnt vmcnt(27) lgkmcnt(6)
    v_mfma_f32_32x32x16_bf16 v[64:79], v[40:43], v[100:103], v[64:79]
    ds_read_b128 v[36:39], v3 offset:9216
    buffer_load_dwordx4 v[180:183], v2, s[44:47], s68 offen offset:1024
    s_waitcnt lgkmcnt(6)
    v_mfma_f32_32x32x16_bf16 v[80:95], v[44:47], v[100:103], v[80:95]
    ds_read_b128 v[40:43], v3 offset:10240
    s_waitcnt vmcnt(27) lgkmcnt(6)
    v_mfma_f32_32x32x16_bf16 v[64:79], v[48:51], v[104:107], v[64:79]
    ds_read_b128 v[44:47], v3 offset:11264
    buffer_load_dwordx4 v[184:187], v2, s[44:47], s68 offen offset:2048
    s_waitcnt lgkmcnt(6)
    v_mfma_f32_32x32x16_bf16 v[80:95], v[52:55], v[104:107], v[80:95]
    ds_read_b128 v[48:51], v3 offset:12288
    s_waitcnt vmcnt(27) lgkmcnt(6)
    v_mfma_f32_32x32x16_bf16 v[64:79], v[56:59], v[108:111], v[64:79]
    ds_read_b128 v[52:55], v3 offset:13312
    buffer_load_dwordx4 v[188:191], v2, s[44:47], s68 offen offset:3072
    s_waitcnt lgkmcnt(6)
    v_mfma_f32_32x32x16_bf16 v[80:95], v[60:63], v[108:111], v[80:95]
    ds_read_b128 v[56:59], v3 offset:14336
    s_waitcnt vmcnt(27) lgkmcnt(6)
    v_mfma_f32_32x32x16_bf16 v[64:79], v[32:35], v[112:115], v[64:79]
    ds_read_b128 v[60:63], v3 offset:15360
    s_add_u32 s68, s68, 4096
    buffer_load_dwordx4 v[96:99], v2, s[44:47], s68 offen offset:0
    s_waitcnt lgkmcnt(6)
    v_mfma_f32_32x32x16_bf16 v[80:95], v[36:39], v[112:115], v[80:95]
    s_barrier
    s_add_u32 m0, s65, 32768
    s_add_u32 s62, s71, 131072
    buffer_load_dwordx4 v1, s[44:47], s62 offen offset:0 lds
    buffer_load_dwordx4 v1, s[44:47], s62 offen offset:1024 lds
    buffer_load_dwordx4 v1, s[44:47], s62 offen offset:2048 lds
    buffer_load_dwordx4 v1, s[44:47], s62 offen offset:3072 lds
    ds_read_b128 v[32:35], v3 offset:16384
    s_waitcnt vmcnt(31) lgkmcnt(6)
    v_mfma_f32_32x32x16_bf16 v[64:79], v[40:43], v[116:119], v[64:79]
    ds_read_b128 v[36:39], v3 offset:17408
    buffer_load_dwordx4 v[100:103], v2, s[44:47], s68 offen offset:1024
    s_waitcnt lgkmcnt(6)
    v_mfma_f32_32x32x16_bf16 v[80:95], v[44:47], v[116:119], v[80:95]
    ds_read_b128 v[40:43], v3 offset:18432
    s_waitcnt vmcnt(31) lgkmcnt(6)
    v_mfma_f32_32x32x16_bf16 v[64:79], v[48:51], v[120:123], v[64:79]
    ds_read_b128 v[44:47], v3 offset:19456
    buffer_load_dwordx4 v[104:107], v2, s[44:47], s68 offen offset:2048
    s_waitcnt lgkmcnt(6)
    v_mfma_f32_32x32x16_bf16 v[80:95], v[52:55], v[120:123], v[80:95]
    ds_read_b128 v[48:51], v3 offset:20480
    s_waitcnt vmcnt(31) lgkmcnt(6)
    v_mfma_f32_32x32x16_bf16 v[64:79], v[56:59], v[124:127], v[64:79]
    ds_read_b128 v[52:55], v3 offset:21504
    buffer_load_dwordx4 v[108:111], v2, s[44:47], s68 offen offset:3072
    s_waitcnt lgkmcnt(6)
    v_mfma_f32_32x32x16_bf16 v[80:95], v[60:63], v[124:127], v[80:95]
    ds_read_b128 v[56:59], v3 offset:22528
    s_waitcnt vmcnt(31) lgkmcnt(6)
    v_mfma_f32_32x32x16_bf16 v[64:79], v[32:35], v[128:131], v[64:79]
    ds_read_b128 v[60:63], v3 offset:23552
    s_add_u32 s68, s68, 4096
    buffer_load_dwordx4 v[112:115], v2, s[44:47], s68 offen offset:0
    s_waitcnt lgkmcnt(6)
    v_mfma_f32_32x32x16_bf16 v[80:95], v[36:39], v[128:131], v[80:95]
    ds_read_b128 v[32:35], v3 offset:24576
    s_waitcnt vmcnt(27) lgkmcnt(6)
    v_mfma_f32_32x32x16_bf16 v[64:79], v[40:43], v[132:135], v[64:79]
    ds_read_b128 v[36:39], v3 offset:25600
    buffer_load_dwordx4 v[116:119], v2, s[44:47], s68 offen offset:1024
    s_waitcnt lgkmcnt(6)
    v_mfma_f32_32x32x16_bf16 v[80:95], v[44:47], v[132:135], v[80:95]
    ds_read_b128 v[40:43], v3 offset:26624
    s_waitcnt vmcnt(27) lgkmcnt(6)
    v_mfma_f32_32x32x16_bf16 v[64:79], v[48:51], v[136:139], v[64:79]
    ds_read_b128 v[44:47], v3 offset:27648
    buffer_load_dwordx4 v[120:123], v2, s[44:47], s68 offen offset:2048
    s_waitcnt lgkmcnt(6)
    v_mfma_f32_32x32x16_bf16 v[80:95], v[52:55], v[136:139], v[80:95]
    ds_read_b128 v[48:51], v3 offset:28672
    s_waitcnt vmcnt(27) lgkmcnt(6)
    v_mfma_f32_32x32x16_bf16 v[64:79], v[56:59], v[140:143], v[64:79]
    ds_read_b128 v[52:55], v3 offset:29696
    buffer_load_dwordx4 v[124:127], v2, s[44:47], s68 offen offset:3072
    s_waitcnt lgkmcnt(6)
    v_mfma_f32_32x32x16_bf16 v[80:95], v[60:63], v[140:143], v[80:95]
    ds_read_b128 v[56:59], v3 offset:30720
    s_waitcnt vmcnt(27) lgkmcnt(6)
    v_mfma_f32_32x32x16_bf16 v[64:79], v[32:35], v[144:147], v[64:79]
    ds_read_b128 v[60:63], v3 offset:31744
    s_add_u32 s68, s68, 4096
    buffer_load_dwordx4 v[128:131], v2, s[44:47], s68 offen offset:0
    s_waitcnt lgkmcnt(6)
    v_mfma_f32_32x32x16_bf16 v[80:95], v[36:39], v[144:147], v[80:95]
    s_barrier
    s_add_u32 m0, s65, 49152
    s_add_u32 s62, s71, 147456
    buffer_load_dwordx4 v1, s[44:47], s62 offen offset:0 lds
    buffer_load_dwordx4 v1, s[44:47], s62 offen offset:1024 lds
    buffer_load_dwordx4 v1, s[44:47], s62 offen offset:2048 lds
    buffer_load_dwordx4 v1, s[44:47], s62 offen offset:3072 lds
    ds_read_b128 v[32:35], v3 offset:32768
    s_waitcnt vmcnt(31) lgkmcnt(6)
    v_mfma_f32_32x32x16_bf16 v[64:79], v[40:43], v[148:151], v[64:79]
    ds_read_b128 v[36:39], v3 offset:33792
    buffer_load_dwordx4 v[132:135], v2, s[44:47], s68 offen offset:1024
    s_waitcnt lgkmcnt(6)
    v_mfma_f32_32x32x16_bf16 v[80:95], v[44:47], v[148:151], v[80:95]
    ds_read_b128 v[40:43], v3 offset:34816
    s_waitcnt vmcnt(31) lgkmcnt(6)
    v_mfma_f32_32x32x16_bf16 v[64:79], v[48:51], v[152:155], v[64:79]
    ds_read_b128 v[44:47], v3 offset:35840
    buffer_load_dwordx4 v[136:139], v2, s[44:47], s68 offen offset:2048
    s_waitcnt lgkmcnt(6)
    v_mfma_f32_32x32x16_bf16 v[80:95], v[52:55], v[152:155], v[80:95]
    ds_read_b128 v[48:51], v3 offset:36864
    s_waitcnt vmcnt(31) lgkmcnt(6)
    v_mfma_f32_32x32x16_bf16 v[64:79], v[56:59], v[156:159], v[64:79]
    ds_read_b128 v[52:55], v3 offset:37888
    buffer_load_dwordx4 v[140:143], v2, s[44:47], s68 offen offset:3072
    s_waitcnt lgkmcnt(6)
    v_mfma_f32_32x32x16_bf16 v[80:95], v[60:63], v[156:159], v[80:95]
    ds_read_b128 v[56:59], v3 offset:38912
    s_waitcnt vmcnt(31) lgkmcnt(6)
    v_mfma_f32_32x32x16_bf16 v[64:79], v[32:35], v[160:163], v[64:79]
    ds_read_b128 v[60:63], v3 offset:39936
    s_add_u32 s68, s68, 4096
    buffer_load_dwordx4 v[144:147], v2, s[44:47], s68 offen offset:0
    s_waitcnt lgkmcnt(6)
    v_mfma_f32_32x32x16_bf16 v[80:95], v[36:39], v[160:163], v[80:95]
    ds_read_b128 v[32:35], v3 offset:40960
    s_waitcnt vmcnt(27) lgkmcnt(6)
    v_mfma_f32_32x32x16_bf16 v[64:79], v[40:43], v[164:167], v[64:79]
    ds_read_b128 v[36:39], v3 offset:41984
    buffer_load_dwordx4 v[148:151], v2, s[44:47], s68 offen offset:1024
    s_waitcnt lgkmcnt(6)
    v_mfma_f32_32x32x16_bf16 v[80:95], v[44:47], v[164:167], v[80:95]
    ds_read_b128 v[40:43], v3 offset:43008
    s_waitcnt vmcnt(27) lgkmcnt(6)
    v_mfma_f32_32x32x16_bf16 v[64:79], v[48:51], v[168:171], v[64:79]
    ds_read_b128 v[44:47], v3 offset:44032
    buffer_load_dwordx4 v[152:155], v2, s[44:47], s68 offen offset:2048
    s_waitcnt lgkmcnt(6)
    v_mfma_f32_32x32x16_bf16 v[80:95], v[52:55], v[168:171], v[80:95]
    ds_read_b128 v[48:51], v3 offset:45056
    s_waitcnt vmcnt(27) lgkmcnt(6)
    v_mfma_f32_32x32x16_bf16 v[64:79], v[56:59], v[172:175], v[64:79]
    ds_read_b128 v[52:55], v3 offset:46080
    buffer_load_dwordx4 v[156:159], v2, s[44:47], s68 offen offset:3072
    s_waitcnt lgkmcnt(6)
    v_mfma_f32_32x32x16_bf16 v[80:95], v[60:63], v[172:175], v[80:95]
    ds_read_b128 v[56:59], v3 offset:47104
    s_waitcnt vmcnt(27) lgkmcnt(6)
    v_mfma_f32_32x32x16_bf16 v[64:79], v[32:35], v[176:179], v[64:79]
    ds_read_b128 v[60:63], v3 offset:48128
    s_add_u32 s68, s68, 4096
    buffer_load_dwordx4 v[160:163], v2, s[44:47], s68 offen offset:0
    s_waitcnt lgkmcnt(6)
    v_mfma_f32_32x32x16_bf16 v[80:95], v[36:39], v[176:179], v[80:95]
    s_barrier
    s_add_u32 m0, s65, 65536
    s_add_u32 s62, s71, 163840
    buffer_load_dwordx4 v1, s[44:47], s62 offen offset:0 lds
    buffer_load_dwordx4 v1, s[44:47], s62 offen offset:1024 lds
    buffer_load_dwordx4 v1, s[44:47], s62 offen offset:2048 lds
    buffer_load_dwordx4 v1, s[44:47], s62 offen offset:3072 lds
    ds_read_b128 v[32:35], v2 offset:0
    s_waitcnt vmcnt(31) lgkmcnt(6)
    v_mfma_f32_32x32x16_bf16 v[64:79], v[40:43], v[180:183], v[64:79]
    ds_read_b128 v[36:39], v2 offset:1024
    buffer_load_dwordx4 v[164:167], v2, s[44:47], s68 offen offset:1024
    s_waitcnt lgkmcnt(6)
    v_mfma_f32_32x32x16_bf16 v[80:95], v[44:47], v[180:183], v[80:95]
    ds_read_b128 v[40:43], v2 offset:2048
    s_waitcnt vmcnt(31) lgkmcnt(6)
    v_mfma_f32_32x32x16_bf16 v[64:79], v[48:51], v[184:187], v[64:79]
    ds_read_b128 v[44:47], v2 offset:3072
    buffer_load_dwordx4 v[168:171], v2, s[44:47], s68 offen offset:2048
    s_waitcnt lgkmcnt(6)
    v_mfma_f32_32x32x16_bf16 v[80:95], v[52:55], v[184:187], v[80:95]
    ds_read_b128 v[48:51], v2 offset:4096
    s_waitcnt vmcnt(31) lgkmcnt(6)
    v_mfma_f32_32x32x16_bf16 v[64:79], v[56:59], v[188:191], v[64:79]
    ds_read_b128 v[52:55], v2 offset:5120
    buffer_load_dwordx4 v[172:175], v2, s[44:47], s68 offen offset:3072
    s_waitcnt lgkmcnt(6)
    v_mfma_f32_32x32x16_bf16 v[80:95], v[60:63], v[188:191], v[80:95]
    ds_read_b128 v[56:59], v2 offset:6144
    s_waitcnt vmcnt(31) lgkmcnt(6)
    v_mfma_f32_32x32x16_bf16 v[64:79], v[32:35], v[96:99], v[64:79]
    ds_read_b128 v[60:63], v2 offset:7168
    s_add_u32 s68, s68, 4096
    buffer_load_dwordx4 v[176:179], v2, s[44:47], s68 offen offset:0
    s_waitcnt lgkmcnt(6)
    v_mfma_f32_32x32x16_bf16 v[80:95], v[36:39], v[96:99], v[80:95]
    ds_read_b128 v[32:35], v2 offset:8192
    s_waitcnt vmcnt(27) lgkmcnt(6)
    v_mfma_f32_32x32x16_bf16 v[64:79], v[40:43], v[100:103], v[64:79]
    ds_read_b128 v[36:39], v2 offset:9216
    buffer_load_dwordx4 v[180:183], v2, s[44:47], s68 offen offset:1024
    s_waitcnt lgkmcnt(6)
    v_mfma_f32_32x32x16_bf16 v[80:95], v[44:47], v[100:103], v[80:95]
    ds_read_b128 v[40:43], v2 offset:10240
    s_waitcnt vmcnt(27) lgkmcnt(6)
    v_mfma_f32_32x32x16_bf16 v[64:79], v[48:51], v[104:107], v[64:79]
    ds_read_b128 v[44:47], v2 offset:11264
    buffer_load_dwordx4 v[184:187], v2, s[44:47], s68 offen offset:2048
    s_waitcnt lgkmcnt(6)
    v_mfma_f32_32x32x16_bf16 v[80:95], v[52:55], v[104:107], v[80:95]
    ds_read_b128 v[48:51], v2 offset:12288
    s_waitcnt vmcnt(27) lgkmcnt(6)
    v_mfma_f32_32x32x16_bf16 v[64:79], v[56:59], v[108:111], v[64:79]
    ds_read_b128 v[52:55], v2 offset:13312
    buffer_load_dwordx4 v[188:191], v2, s[44:47], s68 offen offset:3072
    s_waitcnt lgkmcnt(6)
    v_mfma_f32_32x32x16_bf16 v[80:95], v[60:63], v[108:111], v[80:95]
    ds_read_b128 v[56:59], v2 offset:14336
    s_waitcnt vmcnt(27) lgkmcnt(6)
    v_mfma_f32_32x32x16_bf16 v[64:79], v[32:35], v[112:115], v[64:79]
    ds_read_b128 v[60:63], v2 offset:15360
    s_add_u32 s68, s68, 4096
    buffer_load_dwordx4 v[96:99], v2, s[44:47], s68 offen offset:0
    s_waitcnt lgkmcnt(6)
    v_mfma_f32_32x32x16_bf16 v[80:95], v[36:39], v[112:115], v[80:95]
    s_barrier
    s_add_u32 m0, s65, 81920
    s_add_u32 s62, s71, 180224
    buffer_load_dwordx4 v1, s[44:47], s62 offen offset:0 lds
    buffer_load_dwordx4 v1, s[44:47], s62 offen offset:1024 lds
    buffer_load_dwordx4 v1, s[44:47], s62 offen offset:2048 lds
    buffer_load_dwordx4 v1, s[44:47], s62 offen offset:3072 lds
    ds_read_b128 v[32:35], v2 offset:16384
    s_waitcnt vmcnt(31) lgkmcnt(6)
    v_mfma_f32_32x32x16_bf16 v[64:79], v[40:43], v[116:119], v[64:79]
    ds_read_b128 v[36:39], v2 offset:17408
    buffer_load_dwordx4 v[100:103], v2, s[44:47], s68 offen offset:1024
    s_waitcnt lgkmcnt(6)
    v_mfma_f32_32x32x16_bf16 v[80:95], v[44:47], v[116:119], v[80:95]
    ds_read_b128 v[40:43], v2 offset:18432
    s_waitcnt vmcnt(31) lgkmcnt(6)
    v_mfma_f32_32x32x16_bf16 v[64:79], v[48:51], v[120:123], v[64:79]
    ds_read_b128 v[44:47], v2 offset:19456
    buffer_load_dwordx4 v[104:107], v2, s[44:47], s68 offen offset:2048
    s_waitcnt lgkmcnt(6)
    v_mfma_f32_32x32x16_bf16 v[80:95], v[52:55], v[120:123], v[80:95]
    ds_read_b128 v[48:51], v2 offset:20480
    s_waitcnt vmcnt(31) lgkmcnt(6)
    v_mfma_f32_32x32x16_bf16 v[64:79], v[56:59], v[124:127], v[64:79]
    ds_read_b128 v[52:55], v2 offset:21504
    buffer_load_dwordx4 v[108:111], v2, s[44:47], s68 offen offset:3072
    s_waitcnt lgkmcnt(6)
    v_mfma_f32_32x32x16_bf16 v[80:95], v[60:63], v[124:127], v[80:95]
    ds_read_b128 v[56:59], v2 offset:22528
    s_waitcnt vmcnt(31) lgkmcnt(6)
    v_mfma_f32_32x32x16_bf16 v[64:79], v[32:35], v[128:131], v[64:79]
    ds_read_b128 v[60:63], v2 offset:23552
    s_add_u32 s68, s68, 4096
    buffer_load_dwordx4 v[112:115], v2, s[44:47], s68 offen offset:0
    s_waitcnt lgkmcnt(6)
    v_mfma_f32_32x32x16_bf16 v[80:95], v[36:39], v[128:131], v[80:95]
    ds_read_b128 v[32:35], v2 offset:24576
    s_waitcnt vmcnt(27) lgkmcnt(6)
    v_mfma_f32_32x32x16_bf16 v[64:79], v[40:43], v[132:135], v[64:79]
    ds_read_b128 v[36:39], v2 offset:25600
    buffer_load_dwordx4 v[116:119], v2, s[44:47], s68 offen offset:1024
    s_waitcnt lgkmcnt(6)
    v_mfma_f32_32x32x16_bf16 v[80:95], v[44:47], v[132:135], v[80:95]
    ds_read_b128 v[40:43], v2 offset:26624
    s_waitcnt vmcnt(27) lgkmcnt(6)
    v_mfma_f32_32x32x16_bf16 v[64:79], v[48:51], v[136:139], v[64:79]
    ds_read_b128 v[44:47], v2 offset:27648
    buffer_load_dwordx4 v[120:123], v2, s[44:47], s68 offen offset:2048
    s_waitcnt lgkmcnt(6)
    v_mfma_f32_32x32x16_bf16 v[80:95], v[52:55], v[136:139], v[80:95]
    ds_read_b128 v[48:51], v2 offset:28672
    s_waitcnt vmcnt(27) lgkmcnt(6)
    v_mfma_f32_32x32x16_bf16 v[64:79], v[56:59], v[140:143], v[64:79]
    ds_read_b128 v[52:55], v2 offset:29696
    buffer_load_dwordx4 v[124:127], v2, s[44:47], s68 offen offset:3072
    s_waitcnt lgkmcnt(6)
    v_mfma_f32_32x32x16_bf16 v[80:95], v[60:63], v[140:143], v[80:95]
    ds_read_b128 v[56:59], v2 offset:30720
    s_waitcnt vmcnt(27) lgkmcnt(6)
    v_mfma_f32_32x32x16_bf16 v[64:79], v[32:35], v[144:147], v[64:79]
    ds_read_b128 v[60:63], v2 offset:31744
    s_add_u32 s68, s68, 4096
    buffer_load_dwordx4 v[128:131], v2, s[44:47], s68 offen offset:0
    s_waitcnt lgkmcnt(6)
    v_mfma_f32_32x32x16_bf16 v[80:95], v[36:39], v[144:147], v[80:95]
    s_barrier
    s_add_u32 m0, s65, 0
    s_add_u32 s62, s71, 196608
    buffer_load_dwordx4 v1, s[44:47], s62 offen offset:0 lds
    buffer_load_dwordx4 v1, s[44:47], s62 offen offset:1024 lds
    buffer_load_dwordx4 v1, s[44:47], s62 offen offset:2048 lds
    buffer_load_dwordx4 v1, s[44:47], s62 offen offset:3072 lds
    ds_read_b128 v[32:35], v2 offset:32768
    s_waitcnt vmcnt(31) lgkmcnt(6)
    v_mfma_f32_32x32x16_bf16 v[64:79], v[40:43], v[148:151], v[64:79]
    ds_read_b128 v[36:39], v2 offset:33792
    buffer_load_dwordx4 v[132:135], v2, s[44:47], s68 offen offset:1024
    s_waitcnt lgkmcnt(6)
    v_mfma_f32_32x32x16_bf16 v[80:95], v[44:47], v[148:151], v[80:95]
    ds_read_b128 v[40:43], v2 offset:34816
    s_waitcnt vmcnt(31) lgkmcnt(6)
    v_mfma_f32_32x32x16_bf16 v[64:79], v[48:51], v[152:155], v[64:79]
    ds_read_b128 v[44:47], v2 offset:35840
    buffer_load_dwordx4 v[136:139], v2, s[44:47], s68 offen offset:2048
    s_waitcnt lgkmcnt(6)
    v_mfma_f32_32x32x16_bf16 v[80:95], v[52:55], v[152:155], v[80:95]
    ds_read_b128 v[48:51], v2 offset:36864
    s_waitcnt vmcnt(31) lgkmcnt(6)
    v_mfma_f32_32x32x16_bf16 v[64:79], v[56:59], v[156:159], v[64:79]
    ds_read_b128 v[52:55], v2 offset:37888
    buffer_load_dwordx4 v[140:143], v2, s[44:47], s68 offen offset:3072
    s_waitcnt lgkmcnt(6)
    v_mfma_f32_32x32x16_bf16 v[80:95], v[60:63], v[156:159], v[80:95]
    ds_read_b128 v[56:59], v2 offset:38912
    s_waitcnt vmcnt(31) lgkmcnt(6)
    v_mfma_f32_32x32x16_bf16 v[64:79], v[32:35], v[160:163], v[64:79]
    ds_read_b128 v[60:63], v2 offset:39936
    s_add_u32 s68, s68, 4096
    buffer_load_dwordx4 v[144:147], v2, s[44:47], s68 offen offset:0
    s_waitcnt lgkmcnt(6)
    v_mfma_f32_32x32x16_bf16 v[80:95], v[36:39], v[160:163], v[80:95]
    ds_read_b128 v[32:35], v2 offset:40960
    s_waitcnt vmcnt(27) lgkmcnt(6)
    v_mfma_f32_32x32x16_bf16 v[64:79], v[40:43], v[164:167], v[64:79]
    ds_read_b128 v[36:39], v2 offset:41984
    buffer_load_dwordx4 v[148:151], v2, s[44:47], s68 offen offset:1024
    s_waitcnt lgkmcnt(6)
    v_mfma_f32_32x32x16_bf16 v[80:95], v[44:47], v[164:167], v[80:95]
    ds_read_b128 v[40:43], v2 offset:43008
    s_waitcnt vmcnt(27) lgkmcnt(6)
    v_mfma_f32_32x32x16_bf16 v[64:79], v[48:51], v[168:171], v[64:79]
    ds_read_b128 v[44:47], v2 offset:44032
    buffer_load_dwordx4 v[152:155], v2, s[44:47], s68 offen offset:2048
    s_waitcnt lgkmcnt(6)
    v_mfma_f32_32x32x16_bf16 v[80:95], v[52:55], v[168:171], v[80:95]
    ds_read_b128 v[48:51], v2 offset:45056
    s_waitcnt vmcnt(27) lgkmcnt(6)
    v_mfma_f32_32x32x16_bf16 v[64:79], v[56:59], v[172:175], v[64:79]
    ds_read_b128 v[52:55], v2 offset:46080
    buffer_load_dwordx4 v[156:159], v2, s[44:47], s68 offen offset:3072
    s_waitcnt lgkmcnt(6)
    v_mfma_f32_32x32x16_bf16 v[80:95], v[60:63], v[172:175], v[80:95]
    ds_read_b128 v[56:59], v2 offset:47104
    s_waitcnt vmcnt(27) lgkmcnt(6)
    v_mfma_f32_32x32x16_bf16 v[64:79], v[32:35], v[176:179], v[64:79]
    ds_read_b128 v[60:63], v2 offset:48128
    s_add_u32 s68, s68, 4096
    buffer_load_dwordx4 v[160:163], v2, s[44:47], s68 offen offset:0
    s_waitcnt lgkmcnt(6)
    v_mfma_f32_32x32x16_bf16 v[80:95], v[36:39], v[176:179], v[80:95]
    s_barrier
    s_add_u32 m0, s65, 16384
    s_add_u32 s62, s71, 212992
    buffer_load_dwordx4 v1, s[44:47], s62 offen offset:0 lds
    buffer_load_dwordx4 v1, s[44:47], s62 offen offset:1024 lds
    buffer_load_dwordx4 v1, s[44:47], s62 offen offset:2048 lds
    buffer_load_dwordx4 v1, s[44:47], s62 offen offset:3072 lds
    ds_read_b128 v[32:35], v3 offset:0
    s_waitcnt vmcnt(31) lgkmcnt(6)
    v_mfma_f32_32x32x16_bf16 v[64:79], v[40:43], v[180:183], v[64:79]
    ds_read_b128 v[36:39], v3 offset:1024
    buffer_load_dwordx4 v[164:167], v2, s[44:47], s68 offen offset:1024
    s_waitcnt lgkmcnt(6)
    v_mfma_f32_32x32x16_bf16 v[80:95], v[44:47], v[180:183], v[80:95]
    ds_read_b128 v[40:43], v3 offset:2048
    s_waitcnt vmcnt(31) lgkmcnt(6)
    v_mfma_f32_32x32x16_bf16 v[64:79], v[48:51], v[184:187], v[64:79]
    ds_read_b128 v[44:47], v3 offset:3072
    buffer_load_dwordx4 v[168:171], v2, s[44:47], s68 offen offset:2048
    s_waitcnt lgkmcnt(6)
    v_mfma_f32_32x32x16_bf16 v[80:95], v[52:55], v[184:187], v[80:95]
    ds_read_b128 v[48:51], v3 offset:4096
    s_waitcnt vmcnt(31) lgkmcnt(6)
    v_mfma_f32_32x32x16_bf16 v[64:79], v[56:59], v[188:191], v[64:79]
    ds_read_b128 v[52:55], v3 offset:5120
    buffer_load_dwordx4 v[172:175], v2, s[44:47], s68 offen offset:3072
    s_waitcnt lgkmcnt(6)
    v_mfma_f32_32x32x16_bf16 v[80:95], v[60:63], v[188:191], v[80:95]
    ds_read_b128 v[56:59], v3 offset:6144
    s_waitcnt vmcnt(31) lgkmcnt(6)
    v_mfma_f32_32x32x16_bf16 v[64:79], v[32:35], v[96:99], v[64:79]
    ds_read_b128 v[60:63], v3 offset:7168
    s_add_u32 s68, s68, 4096
    buffer_load_dwordx4 v[176:179], v2, s[44:47], s68 offen offset:0
    s_waitcnt lgkmcnt(6)
    v_mfma_f32_32x32x16_bf16 v[80:95], v[36:39], v[96:99], v[80:95]
    ds_read_b128 v[32:35], v3 offset:8192
    s_waitcnt vmcnt(27) lgkmcnt(6)
    v_mfma_f32_32x32x16_bf16 v[64:79], v[40:43], v[100:103], v[64:79]
    ds_read_b128 v[36:39], v3 offset:9216
    buffer_load_dwordx4 v[180:183], v2, s[44:47], s68 offen offset:1024
    s_waitcnt lgkmcnt(6)
    v_mfma_f32_32x32x16_bf16 v[80:95], v[44:47], v[100:103], v[80:95]
    ds_read_b128 v[40:43], v3 offset:10240
    s_waitcnt vmcnt(27) lgkmcnt(6)
    v_mfma_f32_32x32x16_bf16 v[64:79], v[48:51], v[104:107], v[64:79]
    ds_read_b128 v[44:47], v3 offset:11264
    buffer_load_dwordx4 v[184:187], v2, s[44:47], s68 offen offset:2048
    s_waitcnt lgkmcnt(6)
    v_mfma_f32_32x32x16_bf16 v[80:95], v[52:55], v[104:107], v[80:95]
    ds_read_b128 v[48:51], v3 offset:12288
    s_waitcnt vmcnt(27) lgkmcnt(6)
    v_mfma_f32_32x32x16_bf16 v[64:79], v[56:59], v[108:111], v[64:79]
    ds_read_b128 v[52:55], v3 offset:13312
    buffer_load_dwordx4 v[188:191], v2, s[44:47], s68 offen offset:3072
    s_waitcnt lgkmcnt(6)
    v_mfma_f32_32x32x16_bf16 v[80:95], v[60:63], v[108:111], v[80:95]
    ds_read_b128 v[56:59], v3 offset:14336
    s_waitcnt vmcnt(27) lgkmcnt(6)
    v_mfma_f32_32x32x16_bf16 v[64:79], v[32:35], v[112:115], v[64:79]
    ds_read_b128 v[60:63], v3 offset:15360
    s_add_u32 s68, s68, 4096
    buffer_load_dwordx4 v[96:99], v2, s[44:47], s68 offen offset:0
    s_waitcnt lgkmcnt(6)
    v_mfma_f32_32x32x16_bf16 v[80:95], v[36:39], v[112:115], v[80:95]
    s_barrier
    s_add_u32 m0, s65, 32768
    s_add_u32 s62, s71, 229376
    buffer_load_dwordx4 v1, s[44:47], s62 offen offset:0 lds
    buffer_load_dwordx4 v1, s[44:47], s62 offen offset:1024 lds
    buffer_load_dwordx4 v1, s[44:47], s62 offen offset:2048 lds
    buffer_load_dwordx4 v1, s[44:47], s62 offen offset:3072 lds
    ds_read_b128 v[32:35], v3 offset:16384
    s_waitcnt vmcnt(31) lgkmcnt(6)
    v_mfma_f32_32x32x16_bf16 v[64:79], v[40:43], v[116:119], v[64:79]
    ds_read_b128 v[36:39], v3 offset:17408
    buffer_load_dwordx4 v[100:103], v2, s[44:47], s68 offen offset:1024
    s_waitcnt lgkmcnt(6)
    v_mfma_f32_32x32x16_bf16 v[80:95], v[44:47], v[116:119], v[80:95]
    ds_read_b128 v[40:43], v3 offset:18432
    s_waitcnt vmcnt(31) lgkmcnt(6)
    v_mfma_f32_32x32x16_bf16 v[64:79], v[48:51], v[120:123], v[64:79]
    ds_read_b128 v[44:47], v3 offset:19456
    buffer_load_dwordx4 v[104:107], v2, s[44:47], s68 offen offset:2048
    s_waitcnt lgkmcnt(6)
    v_mfma_f32_32x32x16_bf16 v[80:95], v[52:55], v[120:123], v[80:95]
    ds_read_b128 v[48:51], v3 offset:20480
    s_waitcnt vmcnt(31) lgkmcnt(6)
    v_mfma_f32_32x32x16_bf16 v[64:79], v[56:59], v[124:127], v[64:79]
    ds_read_b128 v[52:55], v3 offset:21504
    buffer_load_dwordx4 v[108:111], v2, s[44:47], s68 offen offset:3072
    s_waitcnt lgkmcnt(6)
    v_mfma_f32_32x32x16_bf16 v[80:95], v[60:63], v[124:127], v[80:95]
    ds_read_b128 v[56:59], v3 offset:22528
    s_waitcnt vmcnt(31) lgkmcnt(6)
    v_mfma_f32_32x32x16_bf16 v[64:79], v[32:35], v[128:131], v[64:79]
    ds_read_b128 v[60:63], v3 offset:23552
    s_add_u32 s68, s68, 4096
    buffer_load_dwordx4 v[112:115], v2, s[44:47], s68 offen offset:0
    s_waitcnt lgkmcnt(6)
    v_mfma_f32_32x32x16_bf16 v[80:95], v[36:39], v[128:131], v[80:95]
    ds_read_b128 v[32:35], v3 offset:24576
    s_waitcnt vmcnt(27) lgkmcnt(6)
    v_mfma_f32_32x32x16_bf16 v[64:79], v[40:43], v[132:135], v[64:79]
    ds_read_b128 v[36:39], v3 offset:25600
    buffer_load_dwordx4 v[116:119], v2, s[44:47], s68 offen offset:1024
    s_waitcnt lgkmcnt(6)
    v_mfma_f32_32x32x16_bf16 v[80:95], v[44:47], v[132:135], v[80:95]
    ds_read_b128 v[40:43], v3 offset:26624
    s_waitcnt vmcnt(27) lgkmcnt(6)
    v_mfma_f32_32x32x16_bf16 v[64:79], v[48:51], v[136:139], v[64:79]
    ds_read_b128 v[44:47], v3 offset:27648
    buffer_load_dwordx4 v[120:123], v2, s[44:47], s68 offen offset:2048
    s_waitcnt lgkmcnt(6)
    v_mfma_f32_32x32x16_bf16 v[80:95], v[52:55], v[136:139], v[80:95]
    ds_read_b128 v[48:51], v3 offset:28672
    s_waitcnt vmcnt(27) lgkmcnt(6)
    v_mfma_f32_32x32x16_bf16 v[64:79], v[56:59], v[140:143], v[64:79]
    ds_read_b128 v[52:55], v3 offset:29696
    buffer_load_dwordx4 v[124:127], v2, s[44:47], s68 offen offset:3072
    s_waitcnt lgkmcnt(6)
    v_mfma_f32_32x32x16_bf16 v[80:95], v[60:63], v[140:143], v[80:95]
    ds_read_b128 v[56:59], v3 offset:30720
    s_waitcnt vmcnt(27) lgkmcnt(6)
    v_mfma_f32_32x32x16_bf16 v[64:79], v[32:35], v[144:147], v[64:79]
    ds_read_b128 v[60:63], v3 offset:31744
    s_add_u32 s68, s68, 4096
    buffer_load_dwordx4 v[128:131], v2, s[44:47], s68 offen offset:0
    s_waitcnt lgkmcnt(6)
    v_mfma_f32_32x32x16_bf16 v[80:95], v[36:39], v[144:147], v[80:95]
    s_barrier
    s_add_u32 m0, s65, 49152
    s_add_u32 s62, s71, 245760
    buffer_load_dwordx4 v1, s[44:47], s62 offen offset:0 lds
    buffer_load_dwordx4 v1, s[44:47], s62 offen offset:1024 lds
    buffer_load_dwordx4 v1, s[44:47], s62 offen offset:2048 lds
    buffer_load_dwordx4 v1, s[44:47], s62 offen offset:3072 lds
    ds_read_b128 v[32:35], v3 offset:32768
    s_waitcnt vmcnt(31) lgkmcnt(6)
    v_mfma_f32_32x32x16_bf16 v[64:79], v[40:43], v[148:151], v[64:79]
    ds_read_b128 v[36:39], v3 offset:33792
    buffer_load_dwordx4 v[132:135], v2, s[44:47], s68 offen offset:1024
    s_waitcnt lgkmcnt(6)
    v_mfma_f32_32x32x16_bf16 v[80:95], v[44:47], v[148:151], v[80:95]
    ds_read_b128 v[40:43], v3 offset:34816
    s_waitcnt vmcnt(31) lgkmcnt(6)
    v_mfma_f32_32x32x16_bf16 v[64:79], v[48:51], v[152:155], v[64:79]
    ds_read_b128 v[44:47], v3 offset:35840
    buffer_load_dwordx4 v[136:139], v2, s[44:47], s68 offen offset:2048
    s_waitcnt lgkmcnt(6)
    v_mfma_f32_32x32x16_bf16 v[80:95], v[52:55], v[152:155], v[80:95]
    ds_read_b128 v[48:51], v3 offset:36864
    s_waitcnt vmcnt(31) lgkmcnt(6)
    v_mfma_f32_32x32x16_bf16 v[64:79], v[56:59], v[156:159], v[64:79]
    ds_read_b128 v[52:55], v3 offset:37888
    buffer_load_dwordx4 v[140:143], v2, s[44:47], s68 offen offset:3072
    s_waitcnt lgkmcnt(6)
    v_mfma_f32_32x32x16_bf16 v[80:95], v[60:63], v[156:159], v[80:95]
    ds_read_b128 v[56:59], v3 offset:38912
    s_waitcnt vmcnt(31) lgkmcnt(6)
    v_mfma_f32_32x32x16_bf16 v[64:79], v[32:35], v[160:163], v[64:79]
    ds_read_b128 v[60:63], v3 offset:39936
    s_add_u32 s68, s68, 4096
    buffer_load_dwordx4 v[144:147], v2, s[44:47], s68 offen offset:0
    s_waitcnt lgkmcnt(6)
    v_mfma_f32_32x32x16_bf16 v[80:95], v[36:39], v[160:163], v[80:95]
    ds_read_b128 v[32:35], v3 offset:40960
    s_waitcnt vmcnt(27) lgkmcnt(6)
    v_mfma_f32_32x32x16_bf16 v[64:79], v[40:43], v[164:167], v[64:79]
    ds_read_b128 v[36:39], v3 offset:41984
    buffer_load_dwordx4 v[148:151], v2, s[44:47], s68 offen offset:1024
    s_waitcnt lgkmcnt(6)
    v_mfma_f32_32x32x16_bf16 v[80:95], v[44:47], v[164:167], v[80:95]
    ds_read_b128 v[40:43], v3 offset:43008
    s_waitcnt vmcnt(27) lgkmcnt(6)
    v_mfma_f32_32x32x16_bf16 v[64:79], v[48:51], v[168:171], v[64:79]
    ds_read_b128 v[44:47], v3 offset:44032
    buffer_load_dwordx4 v[152:155], v2, s[44:47], s68 offen offset:2048
    s_waitcnt lgkmcnt(6)
    v_mfma_f32_32x32x16_bf16 v[80:95], v[52:55], v[168:171], v[80:95]
    ds_read_b128 v[48:51], v3 offset:45056
    s_waitcnt vmcnt(27) lgkmcnt(6)
    v_mfma_f32_32x32x16_bf16 v[64:79], v[56:59], v[172:175], v[64:79]
    ds_read_b128 v[52:55], v3 offset:46080
    buffer_load_dwordx4 v[156:159], v2, s[44:47], s68 offen offset:3072
    s_waitcnt lgkmcnt(6)
    v_mfma_f32_32x32x16_bf16 v[80:95], v[60:63], v[172:175], v[80:95]
    ds_read_b128 v[56:59], v3 offset:47104
    s_waitcnt vmcnt(27) lgkmcnt(6)
    v_mfma_f32_32x32x16_bf16 v[64:79], v[32:35], v[176:179], v[64:79]
    ds_read_b128 v[60:63], v3 offset:48128
    s_add_u32 s68, s68, 4096
    buffer_load_dwordx4 v[160:163], v2, s[44:47], s68 offen offset:0
    s_waitcnt lgkmcnt(6)
    v_mfma_f32_32x32x16_bf16 v[80:95], v[36:39], v[176:179], v[80:95]
    s_barrier
    s_add_u32 m0, s65, 65536
    s_add_u32 s62, s71, 262144
    buffer_load_dwordx4 v1, s[44:47], s62 offen offset:0 lds
    buffer_load_dwordx4 v1, s[44:47], s62 offen offset:1024 lds
    buffer_load_dwordx4 v1, s[44:47], s62 offen offset:2048 lds
    buffer_load_dwordx4 v1, s[44:47], s62 offen offset:3072 lds
    ds_read_b128 v[32:35], v2 offset:0
    s_waitcnt vmcnt(31) lgkmcnt(6)
    v_mfma_f32_32x32x16_bf16 v[64:79], v[40:43], v[180:183], v[64:79]
    ds_read_b128 v[36:39], v2 offset:1024
    buffer_load_dwordx4 v[164:167], v2, s[44:47], s68 offen offset:1024
    s_waitcnt lgkmcnt(6)
    v_mfma_f32_32x32x16_bf16 v[80:95], v[44:47], v[180:183], v[80:95]
    ds_read_b128 v[40:43], v2 offset:2048
    s_waitcnt vmcnt(31) lgkmcnt(6)
    v_mfma_f32_32x32x16_bf16 v[64:79], v[48:51], v[184:187], v[64:79]
    ds_read_b128 v[44:47], v2 offset:3072
    buffer_load_dwordx4 v[168:171], v2, s[44:47], s68 offen offset:2048
    s_waitcnt lgkmcnt(6)
    v_mfma_f32_32x32x16_bf16 v[80:95], v[52:55], v[184:187], v[80:95]
    ds_read_b128 v[48:51], v2 offset:4096
    s_waitcnt vmcnt(31) lgkmcnt(6)
    v_mfma_f32_32x32x16_bf16 v[64:79], v[56:59], v[188:191], v[64:79]
    ds_read_b128 v[52:55], v2 offset:5120
    buffer_load_dwordx4 v[172:175], v2, s[44:47], s68 offen offset:3072
    s_waitcnt lgkmcnt(6)
    v_mfma_f32_32x32x16_bf16 v[80:95], v[60:63], v[188:191], v[80:95]
    ds_read_b128 v[56:59], v2 offset:6144
    s_waitcnt vmcnt(31) lgkmcnt(6)
    v_mfma_f32_32x32x16_bf16 v[64:79], v[32:35], v[96:99], v[64:79]
    ds_read_b128 v[60:63], v2 offset:7168
    s_add_u32 s68, s68, 4096
    buffer_load_dwordx4 v[176:179], v2, s[44:47], s68 offen offset:0
    s_waitcnt lgkmcnt(6)
    v_mfma_f32_32x32x16_bf16 v[80:95], v[36:39], v[96:99], v[80:95]
    ds_read_b128 v[32:35], v2 offset:8192
    s_waitcnt vmcnt(27) lgkmcnt(6)
    v_mfma_f32_32x32x16_bf16 v[64:79], v[40:43], v[100:103], v[64:79]
    ds_read_b128 v[36:39], v2 offset:9216
    buffer_load_dwordx4 v[180:183], v2, s[44:47], s68 offen offset:1024
    s_waitcnt lgkmcnt(6)
    v_mfma_f32_32x32x16_bf16 v[80:95], v[44:47], v[100:103], v[80:95]
    ds_read_b128 v[40:43], v2 offset:10240
    s_waitcnt vmcnt(27) lgkmcnt(6)
    v_mfma_f32_32x32x16_bf16 v[64:79], v[48:51], v[104:107], v[64:79]
    ds_read_b128 v[44:47], v2 offset:11264
    buffer_load_dwordx4 v[184:187], v2, s[44:47], s68 offen offset:2048
    s_waitcnt lgkmcnt(6)
    v_mfma_f32_32x32x16_bf16 v[80:95], v[52:55], v[104:107], v[80:95]
    ds_read_b128 v[48:51], v2 offset:12288
    s_waitcnt vmcnt(27) lgkmcnt(6)
    v_mfma_f32_32x32x16_bf16 v[64:79], v[56:59], v[108:111], v[64:79]
    ds_read_b128 v[52:55], v2 offset:13312
    buffer_load_dwordx4 v[188:191], v2, s[44:47], s68 offen offset:3072
    s_waitcnt lgkmcnt(6)
    v_mfma_f32_32x32x16_bf16 v[80:95], v[60:63], v[108:111], v[80:95]
    ds_read_b128 v[56:59], v2 offset:14336
    s_waitcnt vmcnt(27) lgkmcnt(6)
    v_mfma_f32_32x32x16_bf16 v[64:79], v[32:35], v[112:115], v[64:79]
    ds_read_b128 v[60:63], v2 offset:15360
    s_add_u32 s68, s68, 4096
    buffer_load_dwordx4 v[96:99], v2, s[44:47], s68 offen offset:0
    s_waitcnt lgkmcnt(6)
    v_mfma_f32_32x32x16_bf16 v[80:95], v[36:39], v[112:115], v[80:95]
    s_barrier
    s_add_u32 m0, s65, 81920
    s_add_u32 s62, s71, 278528
    buffer_load_dwordx4 v1, s[44:47], s62 offen offset:0 lds
    buffer_load_dwordx4 v1, s[44:47], s62 offen offset:1024 lds
    buffer_load_dwordx4 v1, s[44:47], s62 offen offset:2048 lds
    buffer_load_dwordx4 v1, s[44:47], s62 offen offset:3072 lds
    ds_read_b128 v[32:35], v2 offset:16384
    s_waitcnt vmcnt(31) lgkmcnt(6)
    v_mfma_f32_32x32x16_bf16 v[64:79], v[40:43], v[116:119], v[64:79]
    ds_read_b128 v[36:39], v2 offset:17408
    buffer_load_dwordx4 v[100:103], v2, s[44:47], s68 offen offset:1024
    s_waitcnt lgkmcnt(6)
    v_mfma_f32_32x32x16_bf16 v[80:95], v[44:47], v[116:119], v[80:95]
    ds_read_b128 v[40:43], v2 offset:18432
    s_waitcnt vmcnt(31) lgkmcnt(6)
    v_mfma_f32_32x32x16_bf16 v[64:79], v[48:51], v[120:123], v[64:79]
    ds_read_b128 v[44:47], v2 offset:19456
    buffer_load_dwordx4 v[104:107], v2, s[44:47], s68 offen offset:2048
    s_waitcnt lgkmcnt(6)
    v_mfma_f32_32x32x16_bf16 v[80:95], v[52:55], v[120:123], v[80:95]
    ds_read_b128 v[48:51], v2 offset:20480
    s_waitcnt vmcnt(31) lgkmcnt(6)
    v_mfma_f32_32x32x16_bf16 v[64:79], v[56:59], v[124:127], v[64:79]
    ds_read_b128 v[52:55], v2 offset:21504
    buffer_load_dwordx4 v[108:111], v2, s[44:47], s68 offen offset:3072
    s_waitcnt lgkmcnt(6)
    v_mfma_f32_32x32x16_bf16 v[80:95], v[60:63], v[124:127], v[80:95]
    ds_read_b128 v[56:59], v2 offset:22528
    s_waitcnt vmcnt(31) lgkmcnt(6)
    v_mfma_f32_32x32x16_bf16 v[64:79], v[32:35], v[128:131], v[64:79]
    ds_read_b128 v[60:63], v2 offset:23552
    s_add_u32 s68, s68, 4096
    buffer_load_dwordx4 v[112:115], v2, s[44:47], s68 offen offset:0
    s_waitcnt lgkmcnt(6)
    v_mfma_f32_32x32x16_bf16 v[80:95], v[36:39], v[128:131], v[80:95]
    ds_read_b128 v[32:35], v2 offset:24576
    s_waitcnt vmcnt(27) lgkmcnt(6)
    v_mfma_f32_32x32x16_bf16 v[64:79], v[40:43], v[132:135], v[64:79]
    ds_read_b128 v[36:39], v2 offset:25600
    buffer_load_dwordx4 v[116:119], v2, s[44:47], s68 offen offset:1024
    s_waitcnt lgkmcnt(6)
    v_mfma_f32_32x32x16_bf16 v[80:95], v[44:47], v[132:135], v[80:95]
    ds_read_b128 v[40:43], v2 offset:26624
    s_waitcnt vmcnt(27) lgkmcnt(6)
    v_mfma_f32_32x32x16_bf16 v[64:79], v[48:51], v[136:139], v[64:79]
    ds_read_b128 v[44:47], v2 offset:27648
    buffer_load_dwordx4 v[120:123], v2, s[44:47], s68 offen offset:2048
    s_waitcnt lgkmcnt(6)
    v_mfma_f32_32x32x16_bf16 v[80:95], v[52:55], v[136:139], v[80:95]
    ds_read_b128 v[48:51], v2 offset:28672
    s_waitcnt vmcnt(27) lgkmcnt(6)
    v_mfma_f32_32x32x16_bf16 v[64:79], v[56:59], v[140:143], v[64:79]
    ds_read_b128 v[52:55], v2 offset:29696
    buffer_load_dwordx4 v[124:127], v2, s[44:47], s68 offen offset:3072
    s_waitcnt lgkmcnt(6)
    v_mfma_f32_32x32x16_bf16 v[80:95], v[60:63], v[140:143], v[80:95]
    ds_read_b128 v[56:59], v2 offset:30720
    s_waitcnt vmcnt(27) lgkmcnt(6)
    v_mfma_f32_32x32x16_bf16 v[64:79], v[32:35], v[144:147], v[64:79]
    ds_read_b128 v[60:63], v2 offset:31744
    s_add_u32 s68, s68, 4096
    buffer_load_dwordx4 v[128:131], v2, s[44:47], s68 offen offset:0
    s_waitcnt lgkmcnt(6)
    v_mfma_f32_32x32x16_bf16 v[80:95], v[36:39], v[144:147], v[80:95]
    s_barrier
    s_add_u32 m0, s65, 0
    s_add_u32 s62, s71, 294912
    buffer_load_dwordx4 v1, s[44:47], s62 offen offset:0 lds
    buffer_load_dwordx4 v1, s[44:47], s62 offen offset:1024 lds
    buffer_load_dwordx4 v1, s[44:47], s62 offen offset:2048 lds
    buffer_load_dwordx4 v1, s[44:47], s62 offen offset:3072 lds
    ds_read_b128 v[32:35], v2 offset:32768
    s_waitcnt vmcnt(31) lgkmcnt(6)
    v_mfma_f32_32x32x16_bf16 v[64:79], v[40:43], v[148:151], v[64:79]
    ds_read_b128 v[36:39], v2 offset:33792
    buffer_load_dwordx4 v[132:135], v2, s[44:47], s68 offen offset:1024
    s_waitcnt lgkmcnt(6)
    v_mfma_f32_32x32x16_bf16 v[80:95], v[44:47], v[148:151], v[80:95]
    ds_read_b128 v[40:43], v2 offset:34816
    s_waitcnt vmcnt(31) lgkmcnt(6)
    v_mfma_f32_32x32x16_bf16 v[64:79], v[48:51], v[152:155], v[64:79]
    ds_read_b128 v[44:47], v2 offset:35840
    buffer_load_dwordx4 v[136:139], v2, s[44:47], s68 offen offset:2048
    s_waitcnt lgkmcnt(6)
    v_mfma_f32_32x32x16_bf16 v[80:95], v[52:55], v[152:155], v[80:95]
    ds_read_b128 v[48:51], v2 offset:36864
    s_waitcnt vmcnt(31) lgkmcnt(6)
    v_mfma_f32_32x32x16_bf16 v[64:79], v[56:59], v[156:159], v[64:79]
    ds_read_b128 v[52:55], v2 offset:37888
    buffer_load_dwordx4 v[140:143], v2, s[44:47], s68 offen offset:3072
    s_waitcnt lgkmcnt(6)
    v_mfma_f32_32x32x16_bf16 v[80:95], v[60:63], v[156:159], v[80:95]
    ds_read_b128 v[56:59], v2 offset:38912
    s_waitcnt vmcnt(31) lgkmcnt(6)
    v_mfma_f32_32x32x16_bf16 v[64:79], v[32:35], v[160:163], v[64:79]
    ds_read_b128 v[60:63], v2 offset:39936
    s_add_u32 s68, s68, 4096
    buffer_load_dwordx4 v[144:147], v2, s[44:47], s68 offen offset:0
    s_waitcnt lgkmcnt(6)
    v_mfma_f32_32x32x16_bf16 v[80:95], v[36:39], v[160:163], v[80:95]
    ds_read_b128 v[32:35], v2 offset:40960
    s_waitcnt vmcnt(27) lgkmcnt(6)
    v_mfma_f32_32x32x16_bf16 v[64:79], v[40:43], v[164:167], v[64:79]
    ds_read_b128 v[36:39], v2 offset:41984
    buffer_load_dwordx4 v[148:151], v2, s[44:47], s68 offen offset:1024
    s_waitcnt lgkmcnt(6)
    v_mfma_f32_32x32x16_bf16 v[80:95], v[44:47], v[164:167], v[80:95]
    ds_read_b128 v[40:43], v2 offset:43008
    s_waitcnt vmcnt(27) lgkmcnt(6)
    v_mfma_f32_32x32x16_bf16 v[64:79], v[48:51], v[168:171], v[64:79]
    ds_read_b128 v[44:47], v2 offset:44032
    buffer_load_dwordx4 v[152:155], v2, s[44:47], s68 offen offset:2048
    s_waitcnt lgkmcnt(6)
    v_mfma_f32_32x32x16_bf16 v[80:95], v[52:55], v[168:171], v[80:95]
    ds_read_b128 v[48:51], v2 offset:45056
    s_waitcnt vmcnt(27) lgkmcnt(6)
    v_mfma_f32_32x32x16_bf16 v[64:79], v[56:59], v[172:175], v[64:79]
    ds_read_b128 v[52:55], v2 offset:46080
    buffer_load_dwordx4 v[156:159], v2, s[44:47], s68 offen offset:3072
    s_waitcnt lgkmcnt(6)
    v_mfma_f32_32x32x16_bf16 v[80:95], v[60:63], v[172:175], v[80:95]
    ds_read_b128 v[56:59], v2 offset:47104
    s_waitcnt vmcnt(27) lgkmcnt(6)
    v_mfma_f32_32x32x16_bf16 v[64:79], v[32:35], v[176:179], v[64:79]
    ds_read_b128 v[60:63], v2 offset:48128
    s_add_u32 s68, s68, 4096
    buffer_load_dwordx4 v[160:163], v2, s[44:47], s68 offen offset:0
    s_waitcnt lgkmcnt(6)
    v_mfma_f32_32x32x16_bf16 v[80:95], v[36:39], v[176:179], v[80:95]
    s_barrier
    s_add_u32 m0, s65, 16384
    s_add_u32 s62, s71, 311296
    buffer_load_dwordx4 v1, s[44:47], s62 offen offset:0 lds
    buffer_load_dwordx4 v1, s[44:47], s62 offen offset:1024 lds
    buffer_load_dwordx4 v1, s[44:47], s62 offen offset:2048 lds
    buffer_load_dwordx4 v1, s[44:47], s62 offen offset:3072 lds
    ds_read_b128 v[32:35], v3 offset:0
    s_waitcnt vmcnt(31) lgkmcnt(6)
    v_mfma_f32_32x32x16_bf16 v[64:79], v[40:43], v[180:183], v[64:79]
    ds_read_b128 v[36:39], v3 offset:1024
    buffer_load_dwordx4 v[164:167], v2, s[44:47], s68 offen offset:1024
    s_waitcnt lgkmcnt(6)
    v_mfma_f32_32x32x16_bf16 v[80:95], v[44:47], v[180:183], v[80:95]
    ds_read_b128 v[40:43], v3 offset:2048
    s_waitcnt vmcnt(31) lgkmcnt(6)
    v_mfma_f32_32x32x16_bf16 v[64:79], v[48:51], v[184:187], v[64:79]
    ds_read_b128 v[44:47], v3 offset:3072
    buffer_load_dwordx4 v[168:171], v2, s[44:47], s68 offen offset:2048
    s_waitcnt lgkmcnt(6)
    v_mfma_f32_32x32x16_bf16 v[80:95], v[52:55], v[184:187], v[80:95]
    ds_read_b128 v[48:51], v3 offset:4096
    s_waitcnt vmcnt(31) lgkmcnt(6)
    v_mfma_f32_32x32x16_bf16 v[64:79], v[56:59], v[188:191], v[64:79]
    ds_read_b128 v[52:55], v3 offset:5120
    buffer_load_dwordx4 v[172:175], v2, s[44:47], s68 offen offset:3072
    s_waitcnt lgkmcnt(6)
    v_mfma_f32_32x32x16_bf16 v[80:95], v[60:63], v[188:191], v[80:95]
    ds_read_b128 v[56:59], v3 offset:6144
    s_waitcnt vmcnt(31) lgkmcnt(6)
    v_mfma_f32_32x32x16_bf16 v[64:79], v[32:35], v[96:99], v[64:79]
    ds_read_b128 v[60:63], v3 offset:7168
    s_add_u32 s68, s68, 4096
    buffer_load_dwordx4 v[176:179], v2, s[44:47], s68 offen offset:0
    s_waitcnt lgkmcnt(6)
    v_mfma_f32_32x32x16_bf16 v[80:95], v[36:39], v[96:99], v[80:95]
    ds_read_b128 v[32:35], v3 offset:8192
    s_waitcnt vmcnt(27) lgkmcnt(6)
    v_mfma_f32_32x32x16_bf16 v[64:79], v[40:43], v[100:103], v[64:79]
    ds_read_b128 v[36:39], v3 offset:9216
    buffer_load_dwordx4 v[180:183], v2, s[44:47], s68 offen offset:1024
    s_waitcnt lgkmcnt(6)
    v_mfma_f32_32x32x16_bf16 v[80:95], v[44:47], v[100:103], v[80:95]
    ds_read_b128 v[40:43], v3 offset:10240
    s_waitcnt vmcnt(27) lgkmcnt(6)
    v_mfma_f32_32x32x16_bf16 v[64:79], v[48:51], v[104:107], v[64:79]
    ds_read_b128 v[44:47], v3 offset:11264
    buffer_load_dwordx4 v[184:187], v2, s[44:47], s68 offen offset:2048
    s_waitcnt lgkmcnt(6)
    v_mfma_f32_32x32x16_bf16 v[80:95], v[52:55], v[104:107], v[80:95]
    ds_read_b128 v[48:51], v3 offset:12288
    s_waitcnt vmcnt(27) lgkmcnt(6)
    v_mfma_f32_32x32x16_bf16 v[64:79], v[56:59], v[108:111], v[64:79]
    ds_read_b128 v[52:55], v3 offset:13312
    buffer_load_dwordx4 v[188:191], v2, s[44:47], s68 offen offset:3072
    s_waitcnt lgkmcnt(6)
    v_mfma_f32_32x32x16_bf16 v[80:95], v[60:63], v[108:111], v[80:95]
    ds_read_b128 v[56:59], v3 offset:14336
    s_waitcnt vmcnt(27) lgkmcnt(6)
    v_mfma_f32_32x32x16_bf16 v[64:79], v[32:35], v[112:115], v[64:79]
    ds_read_b128 v[60:63], v3 offset:15360
    s_add_u32 s68, s68, 4096
    buffer_load_dwordx4 v[96:99], v2, s[44:47], s68 offen offset:0
    s_waitcnt lgkmcnt(6)
    v_mfma_f32_32x32x16_bf16 v[80:95], v[36:39], v[112:115], v[80:95]
    s_barrier
    s_add_u32 m0, s65, 32768
    s_add_u32 s62, s71, 327680
    buffer_load_dwordx4 v1, s[44:47], s62 offen offset:0 lds
    buffer_load_dwordx4 v1, s[44:47], s62 offen offset:1024 lds
    buffer_load_dwordx4 v1, s[44:47], s62 offen offset:2048 lds
    buffer_load_dwordx4 v1, s[44:47], s62 offen offset:3072 lds
    ds_read_b128 v[32:35], v3 offset:16384
    s_waitcnt vmcnt(31) lgkmcnt(6)
    v_mfma_f32_32x32x16_bf16 v[64:79], v[40:43], v[116:119], v[64:79]
    ds_read_b128 v[36:39], v3 offset:17408
    buffer_load_dwordx4 v[100:103], v2, s[44:47], s68 offen offset:1024
    s_waitcnt lgkmcnt(6)
    v_mfma_f32_32x32x16_bf16 v[80:95], v[44:47], v[116:119], v[80:95]
    ds_read_b128 v[40:43], v3 offset:18432
    s_waitcnt vmcnt(31) lgkmcnt(6)
    v_mfma_f32_32x32x16_bf16 v[64:79], v[48:51], v[120:123], v[64:79]
    ds_read_b128 v[44:47], v3 offset:19456
    buffer_load_dwordx4 v[104:107], v2, s[44:47], s68 offen offset:2048
    s_waitcnt lgkmcnt(6)
    v_mfma_f32_32x32x16_bf16 v[80:95], v[52:55], v[120:123], v[80:95]
    ds_read_b128 v[48:51], v3 offset:20480
    s_waitcnt vmcnt(31) lgkmcnt(6)
    v_mfma_f32_32x32x16_bf16 v[64:79], v[56:59], v[124:127], v[64:79]
    ds_read_b128 v[52:55], v3 offset:21504
    buffer_load_dwordx4 v[108:111], v2, s[44:47], s68 offen offset:3072
    s_waitcnt lgkmcnt(6)
    v_mfma_f32_32x32x16_bf16 v[80:95], v[60:63], v[124:127], v[80:95]
    ds_read_b128 v[56:59], v3 offset:22528
    s_waitcnt vmcnt(31) lgkmcnt(6)
    v_mfma_f32_32x32x16_bf16 v[64:79], v[32:35], v[128:131], v[64:79]
    ds_read_b128 v[60:63], v3 offset:23552
    s_add_u32 s68, s68, 4096
    buffer_load_dwordx4 v[112:115], v2, s[44:47], s68 offen offset:0
    s_waitcnt lgkmcnt(6)
    v_mfma_f32_32x32x16_bf16 v[80:95], v[36:39], v[128:131], v[80:95]
    ds_read_b128 v[32:35], v3 offset:24576
    s_waitcnt vmcnt(27) lgkmcnt(6)
    v_mfma_f32_32x32x16_bf16 v[64:79], v[40:43], v[132:135], v[64:79]
    ds_read_b128 v[36:39], v3 offset:25600
    buffer_load_dwordx4 v[116:119], v2, s[44:47], s68 offen offset:1024
    s_waitcnt lgkmcnt(6)
    v_mfma_f32_32x32x16_bf16 v[80:95], v[44:47], v[132:135], v[80:95]
    ds_read_b128 v[40:43], v3 offset:26624
    s_waitcnt vmcnt(27) lgkmcnt(6)
    v_mfma_f32_32x32x16_bf16 v[64:79], v[48:51], v[136:139], v[64:79]
    ds_read_b128 v[44:47], v3 offset:27648
    buffer_load_dwordx4 v[120:123], v2, s[44:47], s68 offen offset:2048
    s_waitcnt lgkmcnt(6)
    v_mfma_f32_32x32x16_bf16 v[80:95], v[52:55], v[136:139], v[80:95]
    ds_read_b128 v[48:51], v3 offset:28672
    s_waitcnt vmcnt(27) lgkmcnt(6)
    v_mfma_f32_32x32x16_bf16 v[64:79], v[56:59], v[140:143], v[64:79]
    ds_read_b128 v[52:55], v3 offset:29696
    buffer_load_dwordx4 v[124:127], v2, s[44:47], s68 offen offset:3072
    s_waitcnt lgkmcnt(6)
    v_mfma_f32_32x32x16_bf16 v[80:95], v[60:63], v[140:143], v[80:95]
    ds_read_b128 v[56:59], v3 offset:30720
    s_waitcnt vmcnt(27) lgkmcnt(6)
    v_mfma_f32_32x32x16_bf16 v[64:79], v[32:35], v[144:147], v[64:79]
    ds_read_b128 v[60:63], v3 offset:31744
    s_add_u32 s68, s68, 4096
    buffer_load_dwordx4 v[128:131], v2, s[44:47], s68 offen offset:0
    s_waitcnt lgkmcnt(6)
    v_mfma_f32_32x32x16_bf16 v[80:95], v[36:39], v[144:147], v[80:95]
    s_barrier
    s_add_u32 m0, s65, 49152
    s_add_u32 s62, s71, 344064
    buffer_load_dwordx4 v1, s[44:47], s62 offen offset:0 lds
    buffer_load_dwordx4 v1, s[44:47], s62 offen offset:1024 lds
    buffer_load_dwordx4 v1, s[44:47], s62 offen offset:2048 lds
    buffer_load_dwordx4 v1, s[44:47], s62 offen offset:3072 lds
    ds_read_b128 v[32:35], v3 offset:32768
    s_waitcnt vmcnt(31) lgkmcnt(6)
    v_mfma_f32_32x32x16_bf16 v[64:79], v[40:43], v[148:151], v[64:79]
    ds_read_b128 v[36:39], v3 offset:33792
    buffer_load_dwordx4 v[132:135], v2, s[44:47], s68 offen offset:1024
    s_waitcnt lgkmcnt(6)
    v_mfma_f32_32x32x16_bf16 v[80:95], v[44:47], v[148:151], v[80:95]
    ds_read_b128 v[40:43], v3 offset:34816
    s_waitcnt vmcnt(31) lgkmcnt(6)
    v_mfma_f32_32x32x16_bf16 v[64:79], v[48:51], v[152:155], v[64:79]
    ds_read_b128 v[44:47], v3 offset:35840
    buffer_load_dwordx4 v[136:139], v2, s[44:47], s68 offen offset:2048
    s_waitcnt lgkmcnt(6)
    v_mfma_f32_32x32x16_bf16 v[80:95], v[52:55], v[152:155], v[80:95]
    ds_read_b128 v[48:51], v3 offset:36864
    s_waitcnt vmcnt(31) lgkmcnt(6)
    v_mfma_f32_32x32x16_bf16 v[64:79], v[56:59], v[156:159], v[64:79]
    ds_read_b128 v[52:55], v3 offset:37888
    buffer_load_dwordx4 v[140:143], v2, s[44:47], s68 offen offset:3072
    s_waitcnt lgkmcnt(6)
    v_mfma_f32_32x32x16_bf16 v[80:95], v[60:63], v[156:159], v[80:95]
    ds_read_b128 v[56:59], v3 offset:38912
    s_waitcnt vmcnt(31) lgkmcnt(6)
    v_mfma_f32_32x32x16_bf16 v[64:79], v[32:35], v[160:163], v[64:79]
    ds_read_b128 v[60:63], v3 offset:39936
    s_add_u32 s68, s68, 4096
    buffer_load_dwordx4 v[144:147], v2, s[44:47], s68 offen offset:0
    s_waitcnt lgkmcnt(6)
    v_mfma_f32_32x32x16_bf16 v[80:95], v[36:39], v[160:163], v[80:95]
    ds_read_b128 v[32:35], v3 offset:40960
    s_waitcnt vmcnt(27) lgkmcnt(6)
    v_mfma_f32_32x32x16_bf16 v[64:79], v[40:43], v[164:167], v[64:79]
    ds_read_b128 v[36:39], v3 offset:41984
    buffer_load_dwordx4 v[148:151], v2, s[44:47], s68 offen offset:1024
    s_waitcnt lgkmcnt(6)
    v_mfma_f32_32x32x16_bf16 v[80:95], v[44:47], v[164:167], v[80:95]
    ds_read_b128 v[40:43], v3 offset:43008
    s_waitcnt vmcnt(27) lgkmcnt(6)
    v_mfma_f32_32x32x16_bf16 v[64:79], v[48:51], v[168:171], v[64:79]
    ds_read_b128 v[44:47], v3 offset:44032
    buffer_load_dwordx4 v[152:155], v2, s[44:47], s68 offen offset:2048
    s_waitcnt lgkmcnt(6)
    v_mfma_f32_32x32x16_bf16 v[80:95], v[52:55], v[168:171], v[80:95]
    ds_read_b128 v[48:51], v3 offset:45056
    s_waitcnt vmcnt(27) lgkmcnt(6)
    v_mfma_f32_32x32x16_bf16 v[64:79], v[56:59], v[172:175], v[64:79]
    ds_read_b128 v[52:55], v3 offset:46080
    buffer_load_dwordx4 v[156:159], v2, s[44:47], s68 offen offset:3072
    s_waitcnt lgkmcnt(6)
    v_mfma_f32_32x32x16_bf16 v[80:95], v[60:63], v[172:175], v[80:95]
    ds_read_b128 v[56:59], v3 offset:47104
    s_waitcnt vmcnt(27) lgkmcnt(6)
    v_mfma_f32_32x32x16_bf16 v[64:79], v[32:35], v[176:179], v[64:79]
    ds_read_b128 v[60:63], v3 offset:48128
    s_add_u32 s68, s68, 4096
    buffer_load_dwordx4 v[160:163], v2, s[44:47], s68 offen offset:0
    s_waitcnt lgkmcnt(6)
    v_mfma_f32_32x32x16_bf16 v[80:95], v[36:39], v[176:179], v[80:95]
    s_barrier
    s_add_u32 m0, s65, 65536
    s_add_u32 s62, s71, 360448
    buffer_load_dwordx4 v1, s[44:47], s62 offen offset:0 lds
    buffer_load_dwordx4 v1, s[44:47], s62 offen offset:1024 lds
    buffer_load_dwordx4 v1, s[44:47], s62 offen offset:2048 lds
    buffer_load_dwordx4 v1, s[44:47], s62 offen offset:3072 lds
    ds_read_b128 v[32:35], v2 offset:0
    s_waitcnt vmcnt(31) lgkmcnt(6)
    v_mfma_f32_32x32x16_bf16 v[64:79], v[40:43], v[180:183], v[64:79]
    ds_read_b128 v[36:39], v2 offset:1024
    buffer_load_dwordx4 v[164:167], v2, s[44:47], s68 offen offset:1024
    s_waitcnt lgkmcnt(6)
    v_mfma_f32_32x32x16_bf16 v[80:95], v[44:47], v[180:183], v[80:95]
    ds_read_b128 v[40:43], v2 offset:2048
    s_waitcnt vmcnt(31) lgkmcnt(6)
    v_mfma_f32_32x32x16_bf16 v[64:79], v[48:51], v[184:187], v[64:79]
    ds_read_b128 v[44:47], v2 offset:3072
    buffer_load_dwordx4 v[168:171], v2, s[44:47], s68 offen offset:2048
    s_waitcnt lgkmcnt(6)
    v_mfma_f32_32x32x16_bf16 v[80:95], v[52:55], v[184:187], v[80:95]
    ds_read_b128 v[48:51], v2 offset:4096
    s_waitcnt vmcnt(31) lgkmcnt(6)
    v_mfma_f32_32x32x16_bf16 v[64:79], v[56:59], v[188:191], v[64:79]
    ds_read_b128 v[52:55], v2 offset:5120
    buffer_load_dwordx4 v[172:175], v2, s[44:47], s68 offen offset:3072
    s_waitcnt lgkmcnt(6)
    v_mfma_f32_32x32x16_bf16 v[80:95], v[60:63], v[188:191], v[80:95]
    ds_read_b128 v[56:59], v2 offset:6144
    s_waitcnt vmcnt(31) lgkmcnt(6)
    v_mfma_f32_32x32x16_bf16 v[64:79], v[32:35], v[96:99], v[64:79]
    ds_read_b128 v[60:63], v2 offset:7168
    s_add_u32 s68, s68, 4096
    buffer_load_dwordx4 v[176:179], v2, s[44:47], s68 offen offset:0
    s_waitcnt lgkmcnt(6)
    v_mfma_f32_32x32x16_bf16 v[80:95], v[36:39], v[96:99], v[80:95]
    ds_read_b128 v[32:35], v2 offset:8192
    s_waitcnt vmcnt(27) lgkmcnt(6)
    v_mfma_f32_32x32x16_bf16 v[64:79], v[40:43], v[100:103], v[64:79]
    ds_read_b128 v[36:39], v2 offset:9216
    buffer_load_dwordx4 v[180:183], v2, s[44:47], s68 offen offset:1024
    s_waitcnt lgkmcnt(6)
    v_mfma_f32_32x32x16_bf16 v[80:95], v[44:47], v[100:103], v[80:95]
    ds_read_b128 v[40:43], v2 offset:10240
    s_waitcnt vmcnt(27) lgkmcnt(6)
    v_mfma_f32_32x32x16_bf16 v[64:79], v[48:51], v[104:107], v[64:79]
    ds_read_b128 v[44:47], v2 offset:11264
    buffer_load_dwordx4 v[184:187], v2, s[44:47], s68 offen offset:2048
    s_waitcnt lgkmcnt(6)
    v_mfma_f32_32x32x16_bf16 v[80:95], v[52:55], v[104:107], v[80:95]
    ds_read_b128 v[48:51], v2 offset:12288
    s_waitcnt vmcnt(27) lgkmcnt(6)
    v_mfma_f32_32x32x16_bf16 v[64:79], v[56:59], v[108:111], v[64:79]
    ds_read_b128 v[52:55], v2 offset:13312
    buffer_load_dwordx4 v[188:191], v2, s[44:47], s68 offen offset:3072
    s_waitcnt lgkmcnt(6)
    v_mfma_f32_32x32x16_bf16 v[80:95], v[60:63], v[108:111], v[80:95]
    ds_read_b128 v[56:59], v2 offset:14336
    s_waitcnt vmcnt(27) lgkmcnt(6)
    v_mfma_f32_32x32x16_bf16 v[64:79], v[32:35], v[112:115], v[64:79]
    ds_read_b128 v[60:63], v2 offset:15360
    s_add_u32 s68, s68, 4096
    buffer_load_dwordx4 v[96:99], v2, s[44:47], s68 offen offset:0
    s_waitcnt lgkmcnt(6)
    v_mfma_f32_32x32x16_bf16 v[80:95], v[36:39], v[112:115], v[80:95]
    s_barrier
    s_add_u32 m0, s65, 81920
    s_add_u32 s62, s71, 376832
    buffer_load_dwordx4 v1, s[44:47], s62 offen offset:0 lds
    buffer_load_dwordx4 v1, s[44:47], s62 offen offset:1024 lds
    buffer_load_dwordx4 v1, s[44:47], s62 offen offset:2048 lds
    buffer_load_dwordx4 v1, s[44:47], s62 offen offset:3072 lds
    ds_read_b128 v[32:35], v2 offset:16384
    s_waitcnt vmcnt(31) lgkmcnt(6)
    v_mfma_f32_32x32x16_bf16 v[64:79], v[40:43], v[116:119], v[64:79]
    ds_read_b128 v[36:39], v2 offset:17408
    buffer_load_dwordx4 v[100:103], v2, s[44:47], s68 offen offset:1024
    s_waitcnt lgkmcnt(6)
    v_mfma_f32_32x32x16_bf16 v[80:95], v[44:47], v[116:119], v[80:95]
    ds_read_b128 v[40:43], v2 offset:18432
    s_waitcnt vmcnt(31) lgkmcnt(6)
    v_mfma_f32_32x32x16_bf16 v[64:79], v[48:51], v[120:123], v[64:79]
    ds_read_b128 v[44:47], v2 offset:19456
    buffer_load_dwordx4 v[104:107], v2, s[44:47], s68 offen offset:2048
    s_waitcnt lgkmcnt(6)
    v_mfma_f32_32x32x16_bf16 v[80:95], v[52:55], v[120:123], v[80:95]
    ds_read_b128 v[48:51], v2 offset:20480
    s_waitcnt vmcnt(31) lgkmcnt(6)
    v_mfma_f32_32x32x16_bf16 v[64:79], v[56:59], v[124:127], v[64:79]
    ds_read_b128 v[52:55], v2 offset:21504
    buffer_load_dwordx4 v[108:111], v2, s[44:47], s68 offen offset:3072
    s_waitcnt lgkmcnt(6)
    v_mfma_f32_32x32x16_bf16 v[80:95], v[60:63], v[124:127], v[80:95]
    ds_read_b128 v[56:59], v2 offset:22528
    s_waitcnt vmcnt(31) lgkmcnt(6)
    v_mfma_f32_32x32x16_bf16 v[64:79], v[32:35], v[128:131], v[64:79]
    ds_read_b128 v[60:63], v2 offset:23552
    s_add_u32 s68, s68, 4096
    buffer_load_dwordx4 v[112:115], v2, s[44:47], s68 offen offset:0
    s_waitcnt lgkmcnt(6)
    v_mfma_f32_32x32x16_bf16 v[80:95], v[36:39], v[128:131], v[80:95]
    ds_read_b128 v[32:35], v2 offset:24576
    s_waitcnt vmcnt(27) lgkmcnt(6)
    v_mfma_f32_32x32x16_bf16 v[64:79], v[40:43], v[132:135], v[64:79]
    ds_read_b128 v[36:39], v2 offset:25600
    buffer_load_dwordx4 v[116:119], v2, s[44:47], s68 offen offset:1024
    s_waitcnt lgkmcnt(6)
    v_mfma_f32_32x32x16_bf16 v[80:95], v[44:47], v[132:135], v[80:95]
    ds_read_b128 v[40:43], v2 offset:26624
    s_waitcnt vmcnt(27) lgkmcnt(6)
    v_mfma_f32_32x32x16_bf16 v[64:79], v[48:51], v[136:139], v[64:79]
    ds_read_b128 v[44:47], v2 offset:27648
    buffer_load_dwordx4 v[120:123], v2, s[44:47], s68 offen offset:2048
    s_waitcnt lgkmcnt(6)
    v_mfma_f32_32x32x16_bf16 v[80:95], v[52:55], v[136:139], v[80:95]
    ds_read_b128 v[48:51], v2 offset:28672
    s_waitcnt vmcnt(27) lgkmcnt(6)
    v_mfma_f32_32x32x16_bf16 v[64:79], v[56:59], v[140:143], v[64:79]
    ds_read_b128 v[52:55], v2 offset:29696
    buffer_load_dwordx4 v[124:127], v2, s[44:47], s68 offen offset:3072
    s_waitcnt lgkmcnt(6)
    v_mfma_f32_32x32x16_bf16 v[80:95], v[60:63], v[140:143], v[80:95]
    ds_read_b128 v[56:59], v2 offset:30720
    s_waitcnt vmcnt(27) lgkmcnt(6)
    v_mfma_f32_32x32x16_bf16 v[64:79], v[32:35], v[144:147], v[64:79]
    ds_read_b128 v[60:63], v2 offset:31744
    s_add_u32 s68, s68, 4096
    buffer_load_dwordx4 v[128:131], v2, s[44:47], s68 offen offset:0
    s_waitcnt lgkmcnt(6)
    v_mfma_f32_32x32x16_bf16 v[80:95], v[36:39], v[144:147], v[80:95]
    s_barrier
    s_add_u32 m0, s65, 0
    s_add_u32 s62, s71, 393216
    buffer_load_dwordx4 v1, s[44:47], s62 offen offset:0 lds
    buffer_load_dwordx4 v1, s[44:47], s62 offen offset:1024 lds
    buffer_load_dwordx4 v1, s[44:47], s62 offen offset:2048 lds
    buffer_load_dwordx4 v1, s[44:47], s62 offen offset:3072 lds
    ds_read_b128 v[32:35], v2 offset:32768
    s_waitcnt vmcnt(31) lgkmcnt(6)
    v_mfma_f32_32x32x16_bf16 v[64:79], v[40:43], v[148:151], v[64:79]
    ds_read_b128 v[36:39], v2 offset:33792
    buffer_load_dwordx4 v[132:135], v2, s[44:47], s68 offen offset:1024
    s_waitcnt lgkmcnt(6)
    v_mfma_f32_32x32x16_bf16 v[80:95], v[44:47], v[148:151], v[80:95]
    ds_read_b128 v[40:43], v2 offset:34816
    s_waitcnt vmcnt(31) lgkmcnt(6)
    v_mfma_f32_32x32x16_bf16 v[64:79], v[48:51], v[152:155], v[64:79]
    ds_read_b128 v[44:47], v2 offset:35840
    buffer_load_dwordx4 v[136:139], v2, s[44:47], s68 offen offset:2048
    s_waitcnt lgkmcnt(6)
    v_mfma_f32_32x32x16_bf16 v[80:95], v[52:55], v[152:155], v[80:95]
    ds_read_b128 v[48:51], v2 offset:36864
    s_waitcnt vmcnt(31) lgkmcnt(6)
    v_mfma_f32_32x32x16_bf16 v[64:79], v[56:59], v[156:159], v[64:79]
    ds_read_b128 v[52:55], v2 offset:37888
    buffer_load_dwordx4 v[140:143], v2, s[44:47], s68 offen offset:3072
    s_waitcnt lgkmcnt(6)
    v_mfma_f32_32x32x16_bf16 v[80:95], v[60:63], v[156:159], v[80:95]
    ds_read_b128 v[56:59], v2 offset:38912
    s_waitcnt vmcnt(31) lgkmcnt(6)
    v_mfma_f32_32x32x16_bf16 v[64:79], v[32:35], v[160:163], v[64:79]
    ds_read_b128 v[60:63], v2 offset:39936
    s_add_u32 s68, s68, 4096
    buffer_load_dwordx4 v[144:147], v2, s[44:47], s68 offen offset:0
    s_waitcnt lgkmcnt(6)
    v_mfma_f32_32x32x16_bf16 v[80:95], v[36:39], v[160:163], v[80:95]
    ds_read_b128 v[32:35], v2 offset:40960
    s_waitcnt vmcnt(27) lgkmcnt(6)
    v_mfma_f32_32x32x16_bf16 v[64:79], v[40:43], v[164:167], v[64:79]
    ds_read_b128 v[36:39], v2 offset:41984
    buffer_load_dwordx4 v[148:151], v2, s[44:47], s68 offen offset:1024
    s_waitcnt lgkmcnt(6)
    v_mfma_f32_32x32x16_bf16 v[80:95], v[44:47], v[164:167], v[80:95]
    ds_read_b128 v[40:43], v2 offset:43008
    s_waitcnt vmcnt(27) lgkmcnt(6)
    v_mfma_f32_32x32x16_bf16 v[64:79], v[48:51], v[168:171], v[64:79]
    ds_read_b128 v[44:47], v2 offset:44032
    buffer_load_dwordx4 v[152:155], v2, s[44:47], s68 offen offset:2048
    s_waitcnt lgkmcnt(6)
    v_mfma_f32_32x32x16_bf16 v[80:95], v[52:55], v[168:171], v[80:95]
    ds_read_b128 v[48:51], v2 offset:45056
    s_waitcnt vmcnt(27) lgkmcnt(6)
    v_mfma_f32_32x32x16_bf16 v[64:79], v[56:59], v[172:175], v[64:79]
    ds_read_b128 v[52:55], v2 offset:46080
    buffer_load_dwordx4 v[156:159], v2, s[44:47], s68 offen offset:3072
    s_waitcnt lgkmcnt(6)
    v_mfma_f32_32x32x16_bf16 v[80:95], v[60:63], v[172:175], v[80:95]
    ds_read_b128 v[56:59], v2 offset:47104
    s_waitcnt vmcnt(27) lgkmcnt(6)
    v_mfma_f32_32x32x16_bf16 v[64:79], v[32:35], v[176:179], v[64:79]
    ds_read_b128 v[60:63], v2 offset:48128
    s_add_u32 s68, s68, 4096
    buffer_load_dwordx4 v[160:163], v2, s[44:47], s68 offen offset:0
    s_waitcnt lgkmcnt(6)
    v_mfma_f32_32x32x16_bf16 v[80:95], v[36:39], v[176:179], v[80:95]
    s_barrier
    s_add_u32 m0, s65, 16384
    s_add_u32 s62, s71, 409600
    buffer_load_dwordx4 v1, s[44:47], s62 offen offset:0 lds
    buffer_load_dwordx4 v1, s[44:47], s62 offen offset:1024 lds
    buffer_load_dwordx4 v1, s[44:47], s62 offen offset:2048 lds
    buffer_load_dwordx4 v1, s[44:47], s62 offen offset:3072 lds
    ds_read_b128 v[32:35], v3 offset:0
    s_waitcnt vmcnt(31) lgkmcnt(6)
    v_mfma_f32_32x32x16_bf16 v[64:79], v[40:43], v[180:183], v[64:79]
    ds_read_b128 v[36:39], v3 offset:1024
    buffer_load_dwordx4 v[164:167], v2, s[44:47], s68 offen offset:1024
    s_waitcnt lgkmcnt(6)
    v_mfma_f32_32x32x16_bf16 v[80:95], v[44:47], v[180:183], v[80:95]
    ds_read_b128 v[40:43], v3 offset:2048
    s_waitcnt vmcnt(31) lgkmcnt(6)
    v_mfma_f32_32x32x16_bf16 v[64:79], v[48:51], v[184:187], v[64:79]
    ds_read_b128 v[44:47], v3 offset:3072
    buffer_load_dwordx4 v[168:171], v2, s[44:47], s68 offen offset:2048
    s_waitcnt lgkmcnt(6)
    v_mfma_f32_32x32x16_bf16 v[80:95], v[52:55], v[184:187], v[80:95]
    ds_read_b128 v[48:51], v3 offset:4096
    s_waitcnt vmcnt(31) lgkmcnt(6)
    v_mfma_f32_32x32x16_bf16 v[64:79], v[56:59], v[188:191], v[64:79]
    ds_read_b128 v[52:55], v3 offset:5120
    buffer_load_dwordx4 v[172:175], v2, s[44:47], s68 offen offset:3072
    s_waitcnt lgkmcnt(6)
    v_mfma_f32_32x32x16_bf16 v[80:95], v[60:63], v[188:191], v[80:95]
    ds_read_b128 v[56:59], v3 offset:6144
    s_waitcnt vmcnt(31) lgkmcnt(6)
    v_mfma_f32_32x32x16_bf16 v[64:79], v[32:35], v[96:99], v[64:79]
    ds_read_b128 v[60:63], v3 offset:7168
    s_add_u32 s68, s68, 4096
    buffer_load_dwordx4 v[176:179], v2, s[44:47], s68 offen offset:0
    s_waitcnt lgkmcnt(6)
    v_mfma_f32_32x32x16_bf16 v[80:95], v[36:39], v[96:99], v[80:95]
    ds_read_b128 v[32:35], v3 offset:8192
    s_waitcnt vmcnt(27) lgkmcnt(6)
    v_mfma_f32_32x32x16_bf16 v[64:79], v[40:43], v[100:103], v[64:79]
    ds_read_b128 v[36:39], v3 offset:9216
    buffer_load_dwordx4 v[180:183], v2, s[44:47], s68 offen offset:1024
    s_waitcnt lgkmcnt(6)
    v_mfma_f32_32x32x16_bf16 v[80:95], v[44:47], v[100:103], v[80:95]
    ds_read_b128 v[40:43], v3 offset:10240
    s_waitcnt vmcnt(27) lgkmcnt(6)
    v_mfma_f32_32x32x16_bf16 v[64:79], v[48:51], v[104:107], v[64:79]
    ds_read_b128 v[44:47], v3 offset:11264
    buffer_load_dwordx4 v[184:187], v2, s[44:47], s68 offen offset:2048
    s_waitcnt lgkmcnt(6)
    v_mfma_f32_32x32x16_bf16 v[80:95], v[52:55], v[104:107], v[80:95]
    ds_read_b128 v[48:51], v3 offset:12288
    s_waitcnt vmcnt(27) lgkmcnt(6)
    v_mfma_f32_32x32x16_bf16 v[64:79], v[56:59], v[108:111], v[64:79]
    ds_read_b128 v[52:55], v3 offset:13312
    buffer_load_dwordx4 v[188:191], v2, s[44:47], s68 offen offset:3072
    s_waitcnt lgkmcnt(6)
    v_mfma_f32_32x32x16_bf16 v[80:95], v[60:63], v[108:111], v[80:95]
    ds_read_b128 v[56:59], v3 offset:14336
    s_waitcnt vmcnt(27) lgkmcnt(6)
    v_mfma_f32_32x32x16_bf16 v[64:79], v[32:35], v[112:115], v[64:79]
    ds_read_b128 v[60:63], v3 offset:15360
    s_add_u32 s68, s68, 4096
    buffer_load_dwordx4 v[96:99], v2, s[44:47], s68 offen offset:0
    s_waitcnt lgkmcnt(6)
    v_mfma_f32_32x32x16_bf16 v[80:95], v[36:39], v[112:115], v[80:95]
    s_barrier
    s_add_u32 m0, s65, 32768
    s_add_u32 s62, s71, 425984
    buffer_load_dwordx4 v1, s[44:47], s62 offen offset:0 lds
    buffer_load_dwordx4 v1, s[44:47], s62 offen offset:1024 lds
    buffer_load_dwordx4 v1, s[44:47], s62 offen offset:2048 lds
    buffer_load_dwordx4 v1, s[44:47], s62 offen offset:3072 lds
    ds_read_b128 v[32:35], v3 offset:16384
    s_waitcnt vmcnt(31) lgkmcnt(6)
    v_mfma_f32_32x32x16_bf16 v[64:79], v[40:43], v[116:119], v[64:79]
    ds_read_b128 v[36:39], v3 offset:17408
    buffer_load_dwordx4 v[100:103], v2, s[44:47], s68 offen offset:1024
    s_waitcnt lgkmcnt(6)
    v_mfma_f32_32x32x16_bf16 v[80:95], v[44:47], v[116:119], v[80:95]
    ds_read_b128 v[40:43], v3 offset:18432
    s_waitcnt vmcnt(31) lgkmcnt(6)
    v_mfma_f32_32x32x16_bf16 v[64:79], v[48:51], v[120:123], v[64:79]
    ds_read_b128 v[44:47], v3 offset:19456
    buffer_load_dwordx4 v[104:107], v2, s[44:47], s68 offen offset:2048
    s_waitcnt lgkmcnt(6)
    v_mfma_f32_32x32x16_bf16 v[80:95], v[52:55], v[120:123], v[80:95]
    ds_read_b128 v[48:51], v3 offset:20480
    s_waitcnt vmcnt(31) lgkmcnt(6)
    v_mfma_f32_32x32x16_bf16 v[64:79], v[56:59], v[124:127], v[64:79]
    ds_read_b128 v[52:55], v3 offset:21504
    buffer_load_dwordx4 v[108:111], v2, s[44:47], s68 offen offset:3072
    s_waitcnt lgkmcnt(6)
    v_mfma_f32_32x32x16_bf16 v[80:95], v[60:63], v[124:127], v[80:95]
    ds_read_b128 v[56:59], v3 offset:22528
    s_waitcnt vmcnt(31) lgkmcnt(6)
    v_mfma_f32_32x32x16_bf16 v[64:79], v[32:35], v[128:131], v[64:79]
    ds_read_b128 v[60:63], v3 offset:23552
    s_add_u32 s68, s68, 4096
    buffer_load_dwordx4 v[112:115], v2, s[44:47], s68 offen offset:0
    s_waitcnt lgkmcnt(6)
    v_mfma_f32_32x32x16_bf16 v[80:95], v[36:39], v[128:131], v[80:95]
    ds_read_b128 v[32:35], v3 offset:24576
    s_waitcnt vmcnt(27) lgkmcnt(6)
    v_mfma_f32_32x32x16_bf16 v[64:79], v[40:43], v[132:135], v[64:79]
    ds_read_b128 v[36:39], v3 offset:25600
    buffer_load_dwordx4 v[116:119], v2, s[44:47], s68 offen offset:1024
    s_waitcnt lgkmcnt(6)
    v_mfma_f32_32x32x16_bf16 v[80:95], v[44:47], v[132:135], v[80:95]
    ds_read_b128 v[40:43], v3 offset:26624
    s_waitcnt vmcnt(27) lgkmcnt(6)
    v_mfma_f32_32x32x16_bf16 v[64:79], v[48:51], v[136:139], v[64:79]
    ds_read_b128 v[44:47], v3 offset:27648
    buffer_load_dwordx4 v[120:123], v2, s[44:47], s68 offen offset:2048
    s_waitcnt lgkmcnt(6)
    v_mfma_f32_32x32x16_bf16 v[80:95], v[52:55], v[136:139], v[80:95]
    ds_read_b128 v[48:51], v3 offset:28672
    s_waitcnt vmcnt(27) lgkmcnt(6)
    v_mfma_f32_32x32x16_bf16 v[64:79], v[56:59], v[140:143], v[64:79]
    ds_read_b128 v[52:55], v3 offset:29696
    buffer_load_dwordx4 v[124:127], v2, s[44:47], s68 offen offset:3072
    s_waitcnt lgkmcnt(6)
    v_mfma_f32_32x32x16_bf16 v[80:95], v[60:63], v[140:143], v[80:95]
    ds_read_b128 v[56:59], v3 offset:30720
    s_waitcnt vmcnt(27) lgkmcnt(6)
    v_mfma_f32_32x32x16_bf16 v[64:79], v[32:35], v[144:147], v[64:79]
    ds_read_b128 v[60:63], v3 offset:31744
    s_add_u32 s68, s68, 4096
    buffer_load_dwordx4 v[128:131], v2, s[44:47], s68 offen offset:0
    s_waitcnt lgkmcnt(6)
    v_mfma_f32_32x32x16_bf16 v[80:95], v[36:39], v[144:147], v[80:95]
    s_barrier
    s_add_u32 m0, s65, 49152
    s_add_u32 s62, s71, 442368
    buffer_load_dwordx4 v1, s[44:47], s62 offen offset:0 lds
    buffer_load_dwordx4 v1, s[44:47], s62 offen offset:1024 lds
    buffer_load_dwordx4 v1, s[44:47], s62 offen offset:2048 lds
    buffer_load_dwordx4 v1, s[44:47], s62 offen offset:3072 lds
    ds_read_b128 v[32:35], v3 offset:32768
    s_waitcnt vmcnt(31) lgkmcnt(6)
    v_mfma_f32_32x32x16_bf16 v[64:79], v[40:43], v[148:151], v[64:79]
    ds_read_b128 v[36:39], v3 offset:33792
    buffer_load_dwordx4 v[132:135], v2, s[44:47], s68 offen offset:1024
    s_waitcnt lgkmcnt(6)
    v_mfma_f32_32x32x16_bf16 v[80:95], v[44:47], v[148:151], v[80:95]
    ds_read_b128 v[40:43], v3 offset:34816
    s_waitcnt vmcnt(31) lgkmcnt(6)
    v_mfma_f32_32x32x16_bf16 v[64:79], v[48:51], v[152:155], v[64:79]
    ds_read_b128 v[44:47], v3 offset:35840
    buffer_load_dwordx4 v[136:139], v2, s[44:47], s68 offen offset:2048
    s_waitcnt lgkmcnt(6)
    v_mfma_f32_32x32x16_bf16 v[80:95], v[52:55], v[152:155], v[80:95]
    ds_read_b128 v[48:51], v3 offset:36864
    s_waitcnt vmcnt(31) lgkmcnt(6)
    v_mfma_f32_32x32x16_bf16 v[64:79], v[56:59], v[156:159], v[64:79]
    ds_read_b128 v[52:55], v3 offset:37888
    buffer_load_dwordx4 v[140:143], v2, s[44:47], s68 offen offset:3072
    s_waitcnt lgkmcnt(6)
    v_mfma_f32_32x32x16_bf16 v[80:95], v[60:63], v[156:159], v[80:95]
    ds_read_b128 v[56:59], v3 offset:38912
    s_waitcnt vmcnt(31) lgkmcnt(6)
    v_mfma_f32_32x32x16_bf16 v[64:79], v[32:35], v[160:163], v[64:79]
    ds_read_b128 v[60:63], v3 offset:39936
    s_add_u32 s68, s68, 4096
    buffer_load_dwordx4 v[144:147], v2, s[44:47], s68 offen offset:0
    s_waitcnt lgkmcnt(6)
    v_mfma_f32_32x32x16_bf16 v[80:95], v[36:39], v[160:163], v[80:95]
    ds_read_b128 v[32:35], v3 offset:40960
    s_waitcnt vmcnt(27) lgkmcnt(6)
    v_mfma_f32_32x32x16_bf16 v[64:79], v[40:43], v[164:167], v[64:79]
    ds_read_b128 v[36:39], v3 offset:41984
    buffer_load_dwordx4 v[148:151], v2, s[44:47], s68 offen offset:1024
    s_waitcnt lgkmcnt(6)
    v_mfma_f32_32x32x16_bf16 v[80:95], v[44:47], v[164:167], v[80:95]
    ds_read_b128 v[40:43], v3 offset:43008
    s_waitcnt vmcnt(27) lgkmcnt(6)
    v_mfma_f32_32x32x16_bf16 v[64:79], v[48:51], v[168:171], v[64:79]
    ds_read_b128 v[44:47], v3 offset:44032
    buffer_load_dwordx4 v[152:155], v2, s[44:47], s68 offen offset:2048
    s_waitcnt lgkmcnt(6)
    v_mfma_f32_32x32x16_bf16 v[80:95], v[52:55], v[168:171], v[80:95]
    ds_read_b128 v[48:51], v3 offset:45056
    s_waitcnt vmcnt(27) lgkmcnt(6)
    v_mfma_f32_32x32x16_bf16 v[64:79], v[56:59], v[172:175], v[64:79]
    ds_read_b128 v[52:55], v3 offset:46080
    buffer_load_dwordx4 v[156:159], v2, s[44:47], s68 offen offset:3072
    s_waitcnt lgkmcnt(6)
    v_mfma_f32_32x32x16_bf16 v[80:95], v[60:63], v[172:175], v[80:95]
    ds_read_b128 v[56:59], v3 offset:47104
    s_waitcnt vmcnt(27) lgkmcnt(6)
    v_mfma_f32_32x32x16_bf16 v[64:79], v[32:35], v[176:179], v[64:79]
    ds_read_b128 v[60:63], v3 offset:48128
    s_add_u32 s68, s68, 4096
    buffer_load_dwordx4 v[160:163], v2, s[44:47], s68 offen offset:0
    s_waitcnt lgkmcnt(6)
    v_mfma_f32_32x32x16_bf16 v[80:95], v[36:39], v[176:179], v[80:95]
    s_barrier
    s_add_u32 m0, s65, 65536
    s_add_u32 s62, s71, 458752
    buffer_load_dwordx4 v1, s[44:47], s62 offen offset:0 lds
    buffer_load_dwordx4 v1, s[44:47], s62 offen offset:1024 lds
    buffer_load_dwordx4 v1, s[44:47], s62 offen offset:2048 lds
    buffer_load_dwordx4 v1, s[44:47], s62 offen offset:3072 lds
    ds_read_b128 v[32:35], v2 offset:0
    s_waitcnt vmcnt(31) lgkmcnt(6)
    v_mfma_f32_32x32x16_bf16 v[64:79], v[40:43], v[180:183], v[64:79]
    ds_read_b128 v[36:39], v2 offset:1024
    buffer_load_dwordx4 v[164:167], v2, s[44:47], s68 offen offset:1024
    s_waitcnt lgkmcnt(6)
    v_mfma_f32_32x32x16_bf16 v[80:95], v[44:47], v[180:183], v[80:95]
    ds_read_b128 v[40:43], v2 offset:2048
    s_waitcnt vmcnt(31) lgkmcnt(6)
    v_mfma_f32_32x32x16_bf16 v[64:79], v[48:51], v[184:187], v[64:79]
    ds_read_b128 v[44:47], v2 offset:3072
    buffer_load_dwordx4 v[168:171], v2, s[44:47], s68 offen offset:2048
    s_waitcnt lgkmcnt(6)
    v_mfma_f32_32x32x16_bf16 v[80:95], v[52:55], v[184:187], v[80:95]
    ds_read_b128 v[48:51], v2 offset:4096
    s_waitcnt vmcnt(31) lgkmcnt(6)
    v_mfma_f32_32x32x16_bf16 v[64:79], v[56:59], v[188:191], v[64:79]
    ds_read_b128 v[52:55], v2 offset:5120
    buffer_load_dwordx4 v[172:175], v2, s[44:47], s68 offen offset:3072
    s_waitcnt lgkmcnt(6)
    v_mfma_f32_32x32x16_bf16 v[80:95], v[60:63], v[188:191], v[80:95]
    ds_read_b128 v[56:59], v2 offset:6144
    s_waitcnt vmcnt(31) lgkmcnt(6)
    v_mfma_f32_32x32x16_bf16 v[64:79], v[32:35], v[96:99], v[64:79]
    ds_read_b128 v[60:63], v2 offset:7168
    s_add_u32 s68, s68, 4096
    buffer_load_dwordx4 v[176:179], v2, s[44:47], s68 offen offset:0
    s_waitcnt lgkmcnt(6)
    v_mfma_f32_32x32x16_bf16 v[80:95], v[36:39], v[96:99], v[80:95]
    ds_read_b128 v[32:35], v2 offset:8192
    s_waitcnt vmcnt(27) lgkmcnt(6)
    v_mfma_f32_32x32x16_bf16 v[64:79], v[40:43], v[100:103], v[64:79]
    ds_read_b128 v[36:39], v2 offset:9216
    buffer_load_dwordx4 v[180:183], v2, s[44:47], s68 offen offset:1024
    s_waitcnt lgkmcnt(6)
    v_mfma_f32_32x32x16_bf16 v[80:95], v[44:47], v[100:103], v[80:95]
    ds_read_b128 v[40:43], v2 offset:10240
    s_waitcnt vmcnt(27) lgkmcnt(6)
    v_mfma_f32_32x32x16_bf16 v[64:79], v[48:51], v[104:107], v[64:79]
    ds_read_b128 v[44:47], v2 offset:11264
    buffer_load_dwordx4 v[184:187], v2, s[44:47], s68 offen offset:2048
    s_waitcnt lgkmcnt(6)
    v_mfma_f32_32x32x16_bf16 v[80:95], v[52:55], v[104:107], v[80:95]
    ds_read_b128 v[48:51], v2 offset:12288
    s_waitcnt vmcnt(27) lgkmcnt(6)
    v_mfma_f32_32x32x16_bf16 v[64:79], v[56:59], v[108:111], v[64:79]
    ds_read_b128 v[52:55], v2 offset:13312
    buffer_load_dwordx4 v[188:191], v2, s[44:47], s68 offen offset:3072
    s_waitcnt lgkmcnt(6)
    v_mfma_f32_32x32x16_bf16 v[80:95], v[60:63], v[108:111], v[80:95]
    ds_read_b128 v[56:59], v2 offset:14336
    s_waitcnt vmcnt(27) lgkmcnt(6)
    v_mfma_f32_32x32x16_bf16 v[64:79], v[32:35], v[112:115], v[64:79]
    ds_read_b128 v[60:63], v2 offset:15360
    s_add_u32 s68, s68, 4096
    buffer_load_dwordx4 v[96:99], v2, s[44:47], s68 offen offset:0
    s_waitcnt lgkmcnt(6)
    v_mfma_f32_32x32x16_bf16 v[80:95], v[36:39], v[112:115], v[80:95]
    s_barrier
    s_add_u32 m0, s65, 81920
    s_add_u32 s62, s71, 475136
    buffer_load_dwordx4 v1, s[44:47], s62 offen offset:0 lds
    buffer_load_dwordx4 v1, s[44:47], s62 offen offset:1024 lds
    buffer_load_dwordx4 v1, s[44:47], s62 offen offset:2048 lds
    buffer_load_dwordx4 v1, s[44:47], s62 offen offset:3072 lds
    ds_read_b128 v[32:35], v2 offset:16384
    s_waitcnt vmcnt(31) lgkmcnt(6)
    v_mfma_f32_32x32x16_bf16 v[64:79], v[40:43], v[116:119], v[64:79]
    ds_read_b128 v[36:39], v2 offset:17408
    buffer_load_dwordx4 v[100:103], v2, s[44:47], s68 offen offset:1024
    s_waitcnt lgkmcnt(6)
    v_mfma_f32_32x32x16_bf16 v[80:95], v[44:47], v[116:119], v[80:95]
    ds_read_b128 v[40:43], v2 offset:18432
    s_waitcnt vmcnt(31) lgkmcnt(6)
    v_mfma_f32_32x32x16_bf16 v[64:79], v[48:51], v[120:123], v[64:79]
    ds_read_b128 v[44:47], v2 offset:19456
    buffer_load_dwordx4 v[104:107], v2, s[44:47], s68 offen offset:2048
    s_waitcnt lgkmcnt(6)
    v_mfma_f32_32x32x16_bf16 v[80:95], v[52:55], v[120:123], v[80:95]
    ds_read_b128 v[48:51], v2 offset:20480
    s_waitcnt vmcnt(31) lgkmcnt(6)
    v_mfma_f32_32x32x16_bf16 v[64:79], v[56:59], v[124:127], v[64:79]
    ds_read_b128 v[52:55], v2 offset:21504
    buffer_load_dwordx4 v[108:111], v2, s[44:47], s68 offen offset:3072
    s_waitcnt lgkmcnt(6)
    v_mfma_f32_32x32x16_bf16 v[80:95], v[60:63], v[124:127], v[80:95]
    ds_read_b128 v[56:59], v2 offset:22528
    s_waitcnt vmcnt(31) lgkmcnt(6)
    v_mfma_f32_32x32x16_bf16 v[64:79], v[32:35], v[128:131], v[64:79]
    ds_read_b128 v[60:63], v2 offset:23552
    s_add_u32 s68, s68, 4096
    buffer_load_dwordx4 v[112:115], v2, s[44:47], s68 offen offset:0
    s_waitcnt lgkmcnt(6)
    v_mfma_f32_32x32x16_bf16 v[80:95], v[36:39], v[128:131], v[80:95]
    ds_read_b128 v[32:35], v2 offset:24576
    s_waitcnt vmcnt(27) lgkmcnt(6)
    v_mfma_f32_32x32x16_bf16 v[64:79], v[40:43], v[132:135], v[64:79]
    ds_read_b128 v[36:39], v2 offset:25600
    buffer_load_dwordx4 v[116:119], v2, s[44:47], s68 offen offset:1024
    s_waitcnt lgkmcnt(6)
    v_mfma_f32_32x32x16_bf16 v[80:95], v[44:47], v[132:135], v[80:95]
    ds_read_b128 v[40:43], v2 offset:26624
    s_waitcnt vmcnt(27) lgkmcnt(6)
    v_mfma_f32_32x32x16_bf16 v[64:79], v[48:51], v[136:139], v[64:79]
    ds_read_b128 v[44:47], v2 offset:27648
    buffer_load_dwordx4 v[120:123], v2, s[44:47], s68 offen offset:2048
    s_waitcnt lgkmcnt(6)
    v_mfma_f32_32x32x16_bf16 v[80:95], v[52:55], v[136:139], v[80:95]
    ds_read_b128 v[48:51], v2 offset:28672
    s_waitcnt vmcnt(27) lgkmcnt(6)
    v_mfma_f32_32x32x16_bf16 v[64:79], v[56:59], v[140:143], v[64:79]
    ds_read_b128 v[52:55], v2 offset:29696
    buffer_load_dwordx4 v[124:127], v2, s[44:47], s68 offen offset:3072
    s_waitcnt lgkmcnt(6)
    v_mfma_f32_32x32x16_bf16 v[80:95], v[60:63], v[140:143], v[80:95]
    ds_read_b128 v[56:59], v2 offset:30720
    s_waitcnt vmcnt(27) lgkmcnt(6)
    v_mfma_f32_32x32x16_bf16 v[64:79], v[32:35], v[144:147], v[64:79]
    ds_read_b128 v[60:63], v2 offset:31744
    s_add_u32 s68, s68, 4096
    buffer_load_dwordx4 v[128:131], v2, s[44:47], s68 offen offset:0
    s_waitcnt lgkmcnt(6)
    v_mfma_f32_32x32x16_bf16 v[80:95], v[36:39], v[144:147], v[80:95]
    s_barrier
    s_add_u32 m0, s65, 0
    s_add_u32 s62, s71, 491520
    buffer_load_dwordx4 v1, s[44:47], s62 offen offset:0 lds
    buffer_load_dwordx4 v1, s[44:47], s62 offen offset:1024 lds
    buffer_load_dwordx4 v1, s[44:47], s62 offen offset:2048 lds
    buffer_load_dwordx4 v1, s[44:47], s62 offen offset:3072 lds
    ds_read_b128 v[32:35], v2 offset:32768
    s_waitcnt vmcnt(31) lgkmcnt(6)
    v_mfma_f32_32x32x16_bf16 v[64:79], v[40:43], v[148:151], v[64:79]
    ds_read_b128 v[36:39], v2 offset:33792
    buffer_load_dwordx4 v[132:135], v2, s[44:47], s68 offen offset:1024
    s_waitcnt lgkmcnt(6)
    v_mfma_f32_32x32x16_bf16 v[80:95], v[44:47], v[148:151], v[80:95]
    ds_read_b128 v[40:43], v2 offset:34816
    s_waitcnt vmcnt(31) lgkmcnt(6)
    v_mfma_f32_32x32x16_bf16 v[64:79], v[48:51], v[152:155], v[64:79]
    ds_read_b128 v[44:47], v2 offset:35840
    buffer_load_dwordx4 v[136:139], v2, s[44:47], s68 offen offset:2048
    s_waitcnt lgkmcnt(6)
    v_mfma_f32_32x32x16_bf16 v[80:95], v[52:55], v[152:155], v[80:95]
    ds_read_b128 v[48:51], v2 offset:36864
    s_waitcnt vmcnt(31) lgkmcnt(6)
    v_mfma_f32_32x32x16_bf16 v[64:79], v[56:59], v[156:159], v[64:79]
    ds_read_b128 v[52:55], v2 offset:37888
    buffer_load_dwordx4 v[140:143], v2, s[44:47], s68 offen offset:3072
    s_waitcnt lgkmcnt(6)
    v_mfma_f32_32x32x16_bf16 v[80:95], v[60:63], v[156:159], v[80:95]
    ds_read_b128 v[56:59], v2 offset:38912
    s_waitcnt vmcnt(31) lgkmcnt(6)
    v_mfma_f32_32x32x16_bf16 v[64:79], v[32:35], v[160:163], v[64:79]
    ds_read_b128 v[60:63], v2 offset:39936
    s_add_u32 s68, s68, 4096
    buffer_load_dwordx4 v[144:147], v2, s[44:47], s68 offen offset:0
    s_waitcnt lgkmcnt(6)
    v_mfma_f32_32x32x16_bf16 v[80:95], v[36:39], v[160:163], v[80:95]
    ds_read_b128 v[32:35], v2 offset:40960
    s_waitcnt vmcnt(27) lgkmcnt(6)
    v_mfma_f32_32x32x16_bf16 v[64:79], v[40:43], v[164:167], v[64:79]
    ds_read_b128 v[36:39], v2 offset:41984
    buffer_load_dwordx4 v[148:151], v2, s[44:47], s68 offen offset:1024
    s_waitcnt lgkmcnt(6)
    v_mfma_f32_32x32x16_bf16 v[80:95], v[44:47], v[164:167], v[80:95]
    ds_read_b128 v[40:43], v2 offset:43008
    s_waitcnt vmcnt(27) lgkmcnt(6)
    v_mfma_f32_32x32x16_bf16 v[64:79], v[48:51], v[168:171], v[64:79]
    ds_read_b128 v[44:47], v2 offset:44032
    buffer_load_dwordx4 v[152:155], v2, s[44:47], s68 offen offset:2048
    s_waitcnt lgkmcnt(6)
    v_mfma_f32_32x32x16_bf16 v[80:95], v[52:55], v[168:171], v[80:95]
    ds_read_b128 v[48:51], v2 offset:45056
    s_waitcnt vmcnt(27) lgkmcnt(6)
    v_mfma_f32_32x32x16_bf16 v[64:79], v[56:59], v[172:175], v[64:79]
    ds_read_b128 v[52:55], v2 offset:46080
    buffer_load_dwordx4 v[156:159], v2, s[44:47], s68 offen offset:3072
    s_waitcnt lgkmcnt(6)
    v_mfma_f32_32x32x16_bf16 v[80:95], v[60:63], v[172:175], v[80:95]
    ds_read_b128 v[56:59], v2 offset:47104
    s_waitcnt vmcnt(27) lgkmcnt(6)
    v_mfma_f32_32x32x16_bf16 v[64:79], v[32:35], v[176:179], v[64:79]
    ds_read_b128 v[60:63], v2 offset:48128
    s_add_u32 s68, s68, 4096
    buffer_load_dwordx4 v[160:163], v2, s[44:47], s68 offen offset:0
    s_waitcnt lgkmcnt(6)
    v_mfma_f32_32x32x16_bf16 v[80:95], v[36:39], v[176:179], v[80:95]
    s_barrier
    s_add_u32 m0, s65, 16384
    s_add_u32 s62, s71, 507904
    buffer_load_dwordx4 v1, s[44:47], s62 offen offset:0 lds
    buffer_load_dwordx4 v1, s[44:47], s62 offen offset:1024 lds
    buffer_load_dwordx4 v1, s[44:47], s62 offen offset:2048 lds
    buffer_load_dwordx4 v1, s[44:47], s62 offen offset:3072 lds
    ds_read_b128 v[32:35], v3 offset:0
    s_waitcnt vmcnt(31) lgkmcnt(6)
    v_mfma_f32_32x32x16_bf16 v[64:79], v[40:43], v[180:183], v[64:79]
    ds_read_b128 v[36:39], v3 offset:1024
    buffer_load_dwordx4 v[164:167], v2, s[44:47], s68 offen offset:1024
    s_waitcnt lgkmcnt(6)
    v_mfma_f32_32x32x16_bf16 v[80:95], v[44:47], v[180:183], v[80:95]
    ds_read_b128 v[40:43], v3 offset:2048
    s_waitcnt vmcnt(31) lgkmcnt(6)
    v_mfma_f32_32x32x16_bf16 v[64:79], v[48:51], v[184:187], v[64:79]
    ds_read_b128 v[44:47], v3 offset:3072
    buffer_load_dwordx4 v[168:171], v2, s[44:47], s68 offen offset:2048
    s_waitcnt lgkmcnt(6)
    v_mfma_f32_32x32x16_bf16 v[80:95], v[52:55], v[184:187], v[80:95]
    ds_read_b128 v[48:51], v3 offset:4096
    s_waitcnt vmcnt(31) lgkmcnt(6)
    v_mfma_f32_32x32x16_bf16 v[64:79], v[56:59], v[188:191], v[64:79]
    ds_read_b128 v[52:55], v3 offset:5120
    buffer_load_dwordx4 v[172:175], v2, s[44:47], s68 offen offset:3072
    s_waitcnt lgkmcnt(6)
    v_mfma_f32_32x32x16_bf16 v[80:95], v[60:63], v[188:191], v[80:95]
    ds_read_b128 v[56:59], v3 offset:6144
    s_waitcnt vmcnt(31) lgkmcnt(6)
    v_mfma_f32_32x32x16_bf16 v[64:79], v[32:35], v[96:99], v[64:79]
    ds_read_b128 v[60:63], v3 offset:7168
    s_add_u32 s68, s68, 4096
    buffer_load_dwordx4 v[176:179], v2, s[44:47], s68 offen offset:0
    s_waitcnt lgkmcnt(6)
    v_mfma_f32_32x32x16_bf16 v[80:95], v[36:39], v[96:99], v[80:95]
    ds_read_b128 v[32:35], v3 offset:8192
    s_waitcnt vmcnt(27) lgkmcnt(6)
    v_mfma_f32_32x32x16_bf16 v[64:79], v[40:43], v[100:103], v[64:79]
    ds_read_b128 v[36:39], v3 offset:9216
    buffer_load_dwordx4 v[180:183], v2, s[44:47], s68 offen offset:1024
    s_waitcnt lgkmcnt(6)
    v_mfma_f32_32x32x16_bf16 v[80:95], v[44:47], v[100:103], v[80:95]
    ds_read_b128 v[40:43], v3 offset:10240
    s_waitcnt vmcnt(27) lgkmcnt(6)
    v_mfma_f32_32x32x16_bf16 v[64:79], v[48:51], v[104:107], v[64:79]
    ds_read_b128 v[44:47], v3 offset:11264
    buffer_load_dwordx4 v[184:187], v2, s[44:47], s68 offen offset:2048
    s_waitcnt lgkmcnt(6)
    v_mfma_f32_32x32x16_bf16 v[80:95], v[52:55], v[104:107], v[80:95]
    ds_read_b128 v[48:51], v3 offset:12288
    s_waitcnt vmcnt(27) lgkmcnt(6)
    v_mfma_f32_32x32x16_bf16 v[64:79], v[56:59], v[108:111], v[64:79]
    ds_read_b128 v[52:55], v3 offset:13312
    buffer_load_dwordx4 v[188:191], v2, s[44:47], s68 offen offset:3072
    s_waitcnt lgkmcnt(6)
    v_mfma_f32_32x32x16_bf16 v[80:95], v[60:63], v[108:111], v[80:95]
    ds_read_b128 v[56:59], v3 offset:14336
    s_waitcnt vmcnt(27) lgkmcnt(6)
    v_mfma_f32_32x32x16_bf16 v[64:79], v[32:35], v[112:115], v[64:79]
    ds_read_b128 v[60:63], v3 offset:15360
    s_add_u32 s68, s68, 4096
    buffer_load_dwordx4 v[96:99], v2, s[44:47], s68 offen offset:0
    s_waitcnt lgkmcnt(6)
    v_mfma_f32_32x32x16_bf16 v[80:95], v[36:39], v[112:115], v[80:95]
    s_barrier
    ds_read_b128 v[32:35], v3 offset:16384
    s_waitcnt vmcnt(27) lgkmcnt(6)
    v_mfma_f32_32x32x16_bf16 v[64:79], v[40:43], v[116:119], v[64:79]
    ds_read_b128 v[36:39], v3 offset:17408
    buffer_load_dwordx4 v[100:103], v2, s[44:47], s68 offen offset:1024
    s_waitcnt lgkmcnt(6)
    v_mfma_f32_32x32x16_bf16 v[80:95], v[44:47], v[116:119], v[80:95]
    ds_read_b128 v[40:43], v3 offset:18432
    s_waitcnt vmcnt(27) lgkmcnt(6)
    v_mfma_f32_32x32x16_bf16 v[64:79], v[48:51], v[120:123], v[64:79]
    ds_read_b128 v[44:47], v3 offset:19456
    buffer_load_dwordx4 v[104:107], v2, s[44:47], s68 offen offset:2048
    s_waitcnt lgkmcnt(6)
    v_mfma_f32_32x32x16_bf16 v[80:95], v[52:55], v[120:123], v[80:95]
    ds_read_b128 v[48:51], v3 offset:20480
    s_waitcnt vmcnt(27) lgkmcnt(6)
    v_mfma_f32_32x32x16_bf16 v[64:79], v[56:59], v[124:127], v[64:79]
    ds_read_b128 v[52:55], v3 offset:21504
    buffer_load_dwordx4 v[108:111], v2, s[44:47], s68 offen offset:3072
    s_waitcnt lgkmcnt(6)
    v_mfma_f32_32x32x16_bf16 v[80:95], v[60:63], v[124:127], v[80:95]
    ds_read_b128 v[56:59], v3 offset:22528
    s_waitcnt vmcnt(27) lgkmcnt(6)
    v_mfma_f32_32x32x16_bf16 v[64:79], v[32:35], v[128:131], v[64:79]
    ds_read_b128 v[60:63], v3 offset:23552
    s_add_u32 s68, s68, 4096
    buffer_load_dwordx4 v[112:115], v2, s[44:47], s68 offen offset:0
    s_waitcnt lgkmcnt(6)
    v_mfma_f32_32x32x16_bf16 v[80:95], v[36:39], v[128:131], v[80:95]
    ds_read_b128 v[32:35], v3 offset:24576
    s_waitcnt vmcnt(23) lgkmcnt(6)
    v_mfma_f32_32x32x16_bf16 v[64:79], v[40:43], v[132:135], v[64:79]
    ds_read_b128 v[36:39], v3 offset:25600
    buffer_load_dwordx4 v[116:119], v2, s[44:47], s68 offen offset:1024
    s_waitcnt lgkmcnt(6)
    v_mfma_f32_32x32x16_bf16 v[80:95], v[44:47], v[132:135], v[80:95]
    ds_read_b128 v[40:43], v3 offset:26624
    s_waitcnt vmcnt(23) lgkmcnt(6)
    v_mfma_f32_32x32x16_bf16 v[64:79], v[48:51], v[136:139], v[64:79]
    ds_read_b128 v[44:47], v3 offset:27648
    buffer_load_dwordx4 v[120:123], v2, s[44:47], s68 offen offset:2048
    s_waitcnt lgkmcnt(6)
    v_mfma_f32_32x32x16_bf16 v[80:95], v[52:55], v[136:139], v[80:95]
    ds_read_b128 v[48:51], v3 offset:28672
    s_waitcnt vmcnt(23) lgkmcnt(6)
    v_mfma_f32_32x32x16_bf16 v[64:79], v[56:59], v[140:143], v[64:79]
    ds_read_b128 v[52:55], v3 offset:29696
    buffer_load_dwordx4 v[124:127], v2, s[44:47], s68 offen offset:3072
    s_waitcnt lgkmcnt(6)
    v_mfma_f32_32x32x16_bf16 v[80:95], v[60:63], v[140:143], v[80:95]
    ds_read_b128 v[56:59], v3 offset:30720
    s_waitcnt vmcnt(23) lgkmcnt(6)
    v_mfma_f32_32x32x16_bf16 v[64:79], v[32:35], v[144:147], v[64:79]
    ds_read_b128 v[60:63], v3 offset:31744
    s_add_u32 s68, s68, 4096
    buffer_load_dwordx4 v[128:131], v2, s[44:47], s68 offen offset:0
    s_waitcnt lgkmcnt(6)
    v_mfma_f32_32x32x16_bf16 v[80:95], v[36:39], v[144:147], v[80:95]
    s_barrier
    ds_read_b128 v[32:35], v3 offset:32768
    s_waitcnt vmcnt(23) lgkmcnt(6)
    v_mfma_f32_32x32x16_bf16 v[64:79], v[40:43], v[148:151], v[64:79]
    ds_read_b128 v[36:39], v3 offset:33792
    buffer_load_dwordx4 v[132:135], v2, s[44:47], s68 offen offset:1024
    s_waitcnt lgkmcnt(6)
    v_mfma_f32_32x32x16_bf16 v[80:95], v[44:47], v[148:151], v[80:95]
    ds_read_b128 v[40:43], v3 offset:34816
    s_waitcnt vmcnt(23) lgkmcnt(6)
    v_mfma_f32_32x32x16_bf16 v[64:79], v[48:51], v[152:155], v[64:79]
    ds_read_b128 v[44:47], v3 offset:35840
    buffer_load_dwordx4 v[136:139], v2, s[44:47], s68 offen offset:2048
    s_waitcnt lgkmcnt(6)
    v_mfma_f32_32x32x16_bf16 v[80:95], v[52:55], v[152:155], v[80:95]
    ds_read_b128 v[48:51], v3 offset:36864
    s_waitcnt vmcnt(23) lgkmcnt(6)
    v_mfma_f32_32x32x16_bf16 v[64:79], v[56:59], v[156:159], v[64:79]
    ds_read_b128 v[52:55], v3 offset:37888
    buffer_load_dwordx4 v[140:143], v2, s[44:47], s68 offen offset:3072
    s_waitcnt lgkmcnt(6)
    v_mfma_f32_32x32x16_bf16 v[80:95], v[60:63], v[156:159], v[80:95]
    ds_read_b128 v[56:59], v3 offset:38912
    s_waitcnt vmcnt(23) lgkmcnt(6)
    v_mfma_f32_32x32x16_bf16 v[64:79], v[32:35], v[160:163], v[64:79]
    ds_read_b128 v[60:63], v3 offset:39936
    s_add_u32 s68, s68, 4096
    buffer_load_dwordx4 v[144:147], v2, s[44:47], s68 offen offset:0
    s_waitcnt lgkmcnt(6)
    v_mfma_f32_32x32x16_bf16 v[80:95], v[36:39], v[160:163], v[80:95]
    ds_read_b128 v[32:35], v3 offset:40960
    s_waitcnt vmcnt(19) lgkmcnt(6)
    v_mfma_f32_32x32x16_bf16 v[64:79], v[40:43], v[164:167], v[64:79]
    ds_read_b128 v[36:39], v3 offset:41984
    buffer_load_dwordx4 v[148:151], v2, s[44:47], s68 offen offset:1024
    s_waitcnt lgkmcnt(6)
    v_mfma_f32_32x32x16_bf16 v[80:95], v[44:47], v[164:167], v[80:95]
    ds_read_b128 v[40:43], v3 offset:43008
    s_waitcnt vmcnt(19) lgkmcnt(6)
    v_mfma_f32_32x32x16_bf16 v[64:79], v[48:51], v[168:171], v[64:79]
    ds_read_b128 v[44:47], v3 offset:44032
    buffer_load_dwordx4 v[152:155], v2, s[44:47], s68 offen offset:2048
    s_waitcnt lgkmcnt(6)
    v_mfma_f32_32x32x16_bf16 v[80:95], v[52:55], v[168:171], v[80:95]
    ds_read_b128 v[48:51], v3 offset:45056
    s_waitcnt vmcnt(19) lgkmcnt(6)
    v_mfma_f32_32x32x16_bf16 v[64:79], v[56:59], v[172:175], v[64:79]
    ds_read_b128 v[52:55], v3 offset:46080
    buffer_load_dwordx4 v[156:159], v2, s[44:47], s68 offen offset:3072
    s_waitcnt lgkmcnt(6)
    v_mfma_f32_32x32x16_bf16 v[80:95], v[60:63], v[172:175], v[80:95]
    ds_read_b128 v[56:59], v3 offset:47104
    s_waitcnt vmcnt(19) lgkmcnt(6)
    v_mfma_f32_32x32x16_bf16 v[64:79], v[32:35], v[176:179], v[64:79]
    ds_read_b128 v[60:63], v3 offset:48128
    s_waitcnt lgkmcnt(6)
    v_mfma_f32_32x32x16_bf16 v[80:95], v[36:39], v[176:179], v[80:95]
    s_barrier
    ds_read_b128 v[32:35], v2 offset:0
    s_waitcnt vmcnt(18) lgkmcnt(6)
    v_mfma_f32_32x32x16_bf16 v[64:79], v[40:43], v[180:183], v[64:79]
    ds_read_b128 v[36:39], v2 offset:1024
    s_waitcnt lgkmcnt(6)
    v_mfma_f32_32x32x16_bf16 v[80:95], v[44:47], v[180:183], v[80:95]
    ds_read_b128 v[40:43], v2 offset:2048
    s_waitcnt vmcnt(17) lgkmcnt(6)
    v_mfma_f32_32x32x16_bf16 v[64:79], v[48:51], v[184:187], v[64:79]
    ds_read_b128 v[44:47], v2 offset:3072
    s_waitcnt lgkmcnt(6)
    v_mfma_f32_32x32x16_bf16 v[80:95], v[52:55], v[184:187], v[80:95]
    ds_read_b128 v[48:51], v2 offset:4096
    s_waitcnt vmcnt(16) lgkmcnt(6)
    v_mfma_f32_32x32x16_bf16 v[64:79], v[56:59], v[188:191], v[64:79]
    ds_read_b128 v[52:55], v2 offset:5120
    s_waitcnt lgkmcnt(6)
    v_mfma_f32_32x32x16_bf16 v[80:95], v[60:63], v[188:191], v[80:95]
    ds_read_b128 v[56:59], v2 offset:6144
    s_waitcnt vmcnt(15) lgkmcnt(6)
    v_mfma_f32_32x32x16_bf16 v[64:79], v[32:35], v[96:99], v[64:79]
    ds_read_b128 v[60:63], v2 offset:7168
    s_waitcnt lgkmcnt(6)
    v_mfma_f32_32x32x16_bf16 v[80:95], v[36:39], v[96:99], v[80:95]
    ds_read_b128 v[32:35], v2 offset:8192
    s_waitcnt vmcnt(14) lgkmcnt(6)
    v_mfma_f32_32x32x16_bf16 v[64:79], v[40:43], v[100:103], v[64:79]
    ds_read_b128 v[36:39], v2 offset:9216
    s_waitcnt lgkmcnt(6)
    v_mfma_f32_32x32x16_bf16 v[80:95], v[44:47], v[100:103], v[80:95]
    ds_read_b128 v[40:43], v2 offset:10240
    s_waitcnt vmcnt(13) lgkmcnt(6)
    v_mfma_f32_32x32x16_bf16 v[64:79], v[48:51], v[104:107], v[64:79]
    ds_read_b128 v[44:47], v2 offset:11264
    s_waitcnt lgkmcnt(6)
    v_mfma_f32_32x32x16_bf16 v[80:95], v[52:55], v[104:107], v[80:95]
    ds_read_b128 v[48:51], v2 offset:12288
    s_waitcnt vmcnt(12) lgkmcnt(6)
    v_mfma_f32_32x32x16_bf16 v[64:79], v[56:59], v[108:111], v[64:79]
    ds_read_b128 v[52:55], v2 offset:13312
    s_waitcnt lgkmcnt(6)
    v_mfma_f32_32x32x16_bf16 v[80:95], v[60:63], v[108:111], v[80:95]
    ds_read_b128 v[56:59], v2 offset:14336
    s_waitcnt vmcnt(11) lgkmcnt(6)
    v_mfma_f32_32x32x16_bf16 v[64:79], v[32:35], v[112:115], v[64:79]
    ds_read_b128 v[60:63], v2 offset:15360
    s_waitcnt lgkmcnt(6)
    v_mfma_f32_32x32x16_bf16 v[80:95], v[36:39], v[112:115], v[80:95]
    s_barrier
    ds_read_b128 v[32:35], v2 offset:16384
    s_waitcnt vmcnt(10) lgkmcnt(6)
    v_mfma_f32_32x32x16_bf16 v[64:79], v[40:43], v[116:119], v[64:79]
    ds_read_b128 v[36:39], v2 offset:17408
    s_waitcnt lgkmcnt(6)
    v_mfma_f32_32x32x16_bf16 v[80:95], v[44:47], v[116:119], v[80:95]
    ds_read_b128 v[40:43], v2 offset:18432
    s_waitcnt vmcnt(9) lgkmcnt(6)
    v_mfma_f32_32x32x16_bf16 v[64:79], v[48:51], v[120:123], v[64:79]
    ds_read_b128 v[44:47], v2 offset:19456
    s_waitcnt lgkmcnt(6)
    v_mfma_f32_32x32x16_bf16 v[80:95], v[52:55], v[120:123], v[80:95]
    ds_read_b128 v[48:51], v2 offset:20480
    s_waitcnt vmcnt(8) lgkmcnt(6)
    v_mfma_f32_32x32x16_bf16 v[64:79], v[56:59], v[124:127], v[64:79]
    ds_read_b128 v[52:55], v2 offset:21504
    s_waitcnt lgkmcnt(6)
    v_mfma_f32_32x32x16_bf16 v[80:95], v[60:63], v[124:127], v[80:95]
    ds_read_b128 v[56:59], v2 offset:22528
    s_waitcnt vmcnt(7) lgkmcnt(6)
    v_mfma_f32_32x32x16_bf16 v[64:79], v[32:35], v[128:131], v[64:79]
    ds_read_b128 v[60:63], v2 offset:23552
    s_waitcnt lgkmcnt(6)
    v_mfma_f32_32x32x16_bf16 v[80:95], v[36:39], v[128:131], v[80:95]
    ds_read_b128 v[32:35], v2 offset:24576
    s_waitcnt vmcnt(6) lgkmcnt(6)
    v_mfma_f32_32x32x16_bf16 v[64:79], v[40:43], v[132:135], v[64:79]
    ds_read_b128 v[36:39], v2 offset:25600
    s_waitcnt lgkmcnt(6)
    v_mfma_f32_32x32x16_bf16 v[80:95], v[44:47], v[132:135], v[80:95]
    ds_read_b128 v[40:43], v2 offset:26624
    s_waitcnt vmcnt(5) lgkmcnt(6)
    v_mfma_f32_32x32x16_bf16 v[64:79], v[48:51], v[136:139], v[64:79]
    ds_read_b128 v[44:47], v2 offset:27648
    s_waitcnt lgkmcnt(6)
    v_mfma_f32_32x32x16_bf16 v[80:95], v[52:55], v[136:139], v[80:95]
    ds_read_b128 v[48:51], v2 offset:28672
    s_waitcnt vmcnt(4) lgkmcnt(6)
    v_mfma_f32_32x32x16_bf16 v[64:79], v[56:59], v[140:143], v[64:79]
    ds_read_b128 v[52:55], v2 offset:29696
    s_waitcnt lgkmcnt(6)
    v_mfma_f32_32x32x16_bf16 v[80:95], v[60:63], v[140:143], v[80:95]
    ds_read_b128 v[56:59], v2 offset:30720
    s_waitcnt vmcnt(3) lgkmcnt(6)
    v_mfma_f32_32x32x16_bf16 v[64:79], v[32:35], v[144:147], v[64:79]
    ds_read_b128 v[60:63], v2 offset:31744
    s_waitcnt lgkmcnt(6)
    v_mfma_f32_32x32x16_bf16 v[80:95], v[36:39], v[144:147], v[80:95]
    s_waitcnt vmcnt(2) lgkmcnt(5)
    v_mfma_f32_32x32x16_bf16 v[64:79], v[40:43], v[148:151], v[64:79]
    s_waitcnt lgkmcnt(4)
    v_mfma_f32_32x32x16_bf16 v[80:95], v[44:47], v[148:151], v[80:95]
    s_waitcnt vmcnt(1) lgkmcnt(3)
    v_mfma_f32_32x32x16_bf16 v[64:79], v[48:51], v[152:155], v[64:79]
    s_waitcnt lgkmcnt(2)
    v_mfma_f32_32x32x16_bf16 v[80:95], v[52:55], v[152:155], v[80:95]
    s_waitcnt vmcnt(0) lgkmcnt(1)
    v_mfma_f32_32x32x16_bf16 v[64:79], v[56:59], v[156:159], v[64:79]
    s_waitcnt lgkmcnt(0)
    v_mfma_f32_32x32x16_bf16 v[80:95], v[60:63], v[156:159], v[80:95]
    s_lshl_b32 s68, s6, 18
    s_lshl_b32 s69, s60, 16
    s_add_u32 s68, s68, s69
    s_lshl_b32 s69, s5, 10
    s_add_u32 s68, s68, s69
    s_add_u32 s68, s68, s64
    v_and_b32 v8, 31, v0
    v_lshlrev_b32 v8, 11, v8
    v_lshrrev_b32 v9, 5, v0
    v_lshlrev_b32 v9, 4, v9
    v_add_u32 v8, v8, v9
    v_cvt_pk_bf16_f32 v64, v64, v65
    v_cvt_pk_bf16_f32 v65, v66, v67
    v_cvt_pk_bf16_f32 v66, v68, v69
    v_cvt_pk_bf16_f32 v67, v70, v71
    v_cvt_pk_bf16_f32 v68, v72, v73
    v_cvt_pk_bf16_f32 v69, v74, v75
    v_cvt_pk_bf16_f32 v70, v76, v77
    v_cvt_pk_bf16_f32 v71, v78, v79
    v_cvt_pk_bf16_f32 v72, v80, v81
    v_cvt_pk_bf16_f32 v73, v82, v83
    v_cvt_pk_bf16_f32 v74, v84, v85
    v_cvt_pk_bf16_f32 v75, v86, v87
    v_cvt_pk_bf16_f32 v76, v88, v89
    v_cvt_pk_bf16_f32 v77, v90, v91
    v_cvt_pk_bf16_f32 v78, v92, v93
    v_cvt_pk_bf16_f32 v79, v94, v95
    v_permlane32_swap_b32 v64, v66
    v_permlane32_swap_b32 v65, v67
    v_permlane32_swap_b32 v68, v70
    v_permlane32_swap_b32 v69, v71
    v_permlane32_swap_b32 v72, v74
    v_permlane32_swap_b32 v73, v75
    v_permlane32_swap_b32 v76, v78
    v_permlane32_swap_b32 v77, v79
    buffer_store_dwordx4 v[64:67], v8, s[48:51], s68 offen offset:0
    buffer_store_dwordx4 v[68:71], v8, s[48:51], s68 offen offset:32
    buffer_store_dwordx4 v[72:75], v8, s[48:51], s68 offen offset:64
    buffer_store_dwordx4 v[76:79], v8, s[48:51], s68 offen offset:96
L_oproj_end:
    s_endpgm
.section .rodata,"a"
.p2align 6
.amdhsa_kernel prep_kernel
  .amdhsa_next_free_vgpr 64
  .amdhsa_next_free_sgpr 102
  .amdhsa_accum_offset 64
  .amdhsa_group_segment_fixed_size 0
  .amdhsa_kernarg_size 104
  .amdhsa_user_sgpr_count 2
  .amdhsa_user_sgpr_kernarg_segment_ptr 1
  .amdhsa_system_sgpr_workgroup_id_x 1
.end_amdhsa_kernel
.p2align 6
.amdhsa_kernel attn_kernel
  .amdhsa_next_free_vgpr 256
  .amdhsa_next_free_sgpr 102
  .amdhsa_accum_offset 256
  .amdhsa_group_segment_fixed_size 0
  .amdhsa_kernarg_size 104
  .amdhsa_user_sgpr_count 2
  .amdhsa_user_sgpr_kernarg_segment_ptr 1
  .amdhsa_system_sgpr_workgroup_id_x 1
.end_amdhsa_kernel
.p2align 6
.amdhsa_kernel oproj_kernel
  .amdhsa_next_free_vgpr 256
  .amdhsa_next_free_sgpr 102
  .amdhsa_accum_offset 256
  .amdhsa_group_segment_fixed_size 0
  .amdhsa_kernarg_size 104
  .amdhsa_user_sgpr_count 2
  .amdhsa_user_sgpr_kernarg_segment_ptr 1
  .amdhsa_system_sgpr_workgroup_id_x 1
.end_amdhsa_kernel
```
